```python
import torch

def _softmax(x, axis=-1):
    return torch.softmax(x, dim=axis)
def _gelu(x):
    return torch.nn.functional.gelu(x, approximate="tanh")
def _silu(x):
    return torch.nn.functional.silu(x)
def _sigmoid(x):
    return torch.sigmoid(x)
def _layernorm(x, axis=-1, eps=1e-5):
    m = x.mean(dim=axis, keepdim=True)
    v = x.var(dim=axis, keepdim=True, unbiased=False)
    return (x - m) / torch.sqrt(v + eps)
def _scatter_add(tgt, idx, src, axis=0):
    return tgt.clone().index_add_(axis, idx, src)
def _segment_sum(src, seg, n):
    out = torch.zeros((n,) + src.shape[1:], dtype=src.dtype)
    return out.index_add_(0, seg, src)
def _pad(x, pw):
    flat = tuple(v for pair in reversed(pw) for v in pair)
    return torch.nn.functional.pad(x, flat)

kernel_name = 'gated_mix__mha_block_cached__mixer_token_mlp__decode'

def setup_inputs():

    _w = (lambda a: (lambda t: t.to(torch.bfloat16) if t.is_floating_point() else t)(torch.as_tensor(a)))
    def _A_setup():
        B, Sq, D = 8, 1, 512
        H, Sk, Dh = 32, 4096, 128
        return {
            "x": _w((lambda *s: torch.randn(*s, dtype=torch.bfloat16) * 0.05)(B, Sq, D)),
            "k_cache": _w((lambda *s: torch.randn(*s, dtype=torch.bfloat16) * 6.4)(B, H, Sk, Dh)),
            "v_cache": _w((lambda *s: torch.randn(*s, dtype=torch.bfloat16) * 1.6)(B, H, Sk, Dh)),
            "wq": _w((lambda *s: torch.randn(*s, dtype=torch.bfloat16) * 6.4)(D, H * Dh) * (D ** -0.5)),
            "wo": _w((lambda *s: torch.randn(*s, dtype=torch.bfloat16) * 1.6)(H * Dh, D) * ((H * Dh) ** -0.5)),
        }
    _A_in = _A_setup()

    def _B_setup():
        B, S, D, F = 8, 1, 512, 1792
        return {
            "x": _w((lambda *s: torch.randn(*s, dtype=torch.bfloat16) * 0.05)(B, S, D)),
            "w1": _w((lambda *s: torch.randn(*s, dtype=torch.bfloat16) * 3.2)(S, F) * (S ** -0.5)),
            "b1": _w((lambda *s: torch.randn(*s, dtype=torch.bfloat16) * 3.2)(F) * 0.02),
            "w2": _w((lambda *s: torch.randn(*s, dtype=torch.bfloat16) * 0.1)(F, S) * (F ** -0.5)),
            "b2": _w((lambda *s: torch.randn(*s, dtype=torch.bfloat16) * 0.1)(S) * 0.02),
        }
    _B_in = _B_setup()

    return {
        "A_x": _A_in["x"],
        "A_k_cache": _A_in["k_cache"],
        "A_v_cache": _A_in["v_cache"],
        "A_wq": _A_in["wq"],
        "A_wo": _A_in["wo"],
        "B_x": _B_in["x"],
        "B_w1": _B_in["w1"],
        "B_b1": _B_in["b1"],
        "B_w2": _B_in["w2"],
        "B_b2": _B_in["b2"],
        "gate_w": _w((lambda *s: torch.randn(*s, dtype=torch.bfloat16) * 0.05)(512) * 16.0),
    }

def reference(A_x, A_k_cache, A_v_cache, A_wq, A_wo, B_x, B_w1, B_b1, B_w2, B_b2, gate_w):
    def _A_ref(x, k_cache, v_cache, wq, wo):
        B, Sq, D = x.shape
        H, Dh = 32, 128
        q = (lambda x, *d: x.permute(*d))((x @ wq).reshape(B, Sq, H, Dh), 0, 2, 1, 3)
        scores = torch.einsum("bhqd,bhkd->bhqk", q, k_cache) * (Dh ** -0.5)
        p = _softmax(scores, axis=-1)
        o = torch.einsum("bhqk,bhkd->bhqd", p, v_cache)
        return (lambda x, *d: x.permute(*d))(o, 0, 2, 1, 3).reshape(B, Sq, H * Dh) @ wo

    def _B_ref(x, w1, b1, w2, b2):
        B, S, D = x.shape
        h = _layernorm(x, axis=-1)
        u = torch.einsum("bsd,sf->bdf", h, w1) + b1
        u = _gelu(u)
        y = torch.einsum("bdf,fs->bds", u, w2) + b2
        return (lambda x, *d: x.permute(*d))(y, 0, 2, 1)

    x = A_x
    g = _sigmoid((x * gate_w).sum(-1, keepdims=True))
    a = _A_ref(x, A_k_cache, A_v_cache, A_wq, A_wo)
    b = _B_ref(x, B_w1, B_b1, B_w2, B_b2)
    return g * a + (1 - g) * b
```

```asm
; @launch grid=(256,1,1) block=(512,1,1) lds=24576
.amdgcn_target "amdgcn-amd-amdhsa--gfx950"
.text
.globl gated_mix__mha_block_cached__mixer_token_mlp__decode_kernel
.p2align 8
.type gated_mix__mha_block_cached__mixer_token_mlp__decode_kernel,@function
gated_mix__mha_block_cached__mixer_token_mlp__decode_kernel:
    s_cmp_ge_u32 s2, 256
    s_cbranch_scc1 L_done
    v_lshrrev_b32 v1, 6, v0
    v_and_b32 v0, 63, v0
    v_readfirstlane_b32 s3, v1
    s_nop 0
    s_cmp_ge_u32 s3, 4
    s_cbranch_scc1 L_args_aux
    s_load_dwordx4 s[12:15], s[0:1], 8
    s_branch L_args_done
L_args_aux:
    s_load_dwordx16 s[8:23], s[0:1], 0
    s_load_dwordx8 s[24:31], s[0:1], 64
    s_load_dwordx4 s[32:35], s[0:1], 96
L_args_done:
    s_lshr_b32 s36, s2, 3
    s_and_b32 s36, s36, 7
    s_lshr_b32 s37, s2, 6
    s_lshl_b32 s37, s37, 3
    s_and_b32 s46, s2, 7
    s_or_b32 s37, s37, s46
    s_lshl_b32 s51, s36, 5
    s_or_b32 s51, s51, s37
    s_and_b32 s38, s3, 3
    s_mov_b32 s39, 0xffff0000
    s_mov_b32 s44, 0x3fb8aa3b
    s_cmp_ge_u32 s3, 4
    s_cbranch_scc1 L_aux
    s_setprio 2
    v_lshlrev_b32 v1, 4, v0
    s_lshl_b32 s46, s38, 12
    v_add_u32 v1, s46, v1
    s_lshl_b32 s46, s51, 20
    s_lshr_b32 s47, s51, 12
    s_mov_b32 s72, 0
    s_mov_b32 s73, 0
    s_waitcnt lgkmcnt(0)
    s_add_u32 s52, s12, s46
    s_addc_u32 s53, s13, s47
    s_mov_b32 s54, 1048576
    s_mov_b32 s55, 0x20000
    s_add_u32 s56, s14, s46
    s_addc_u32 s57, s15, s47
    s_mov_b32 s58, 1048576
    s_mov_b32 s59, 0x20000
    buffer_load_dwordx4 v[64:67], v1, s[52:55], s72 offen offset:0 nt
    buffer_load_dwordx4 v[68:71], v1, s[52:55], s72 offen offset:1024 nt
    buffer_load_dwordx4 v[72:75], v1, s[52:55], s72 offen offset:2048 nt
    buffer_load_dwordx4 v[76:79], v1, s[52:55], s72 offen offset:3072 nt
    s_add_u32 s72, s72, 16384
    buffer_load_dwordx4 v[80:83], v1, s[52:55], s72 offen offset:0 nt
    buffer_load_dwordx4 v[84:87], v1, s[52:55], s72 offen offset:1024 nt
    s_mov_b32 s40, 0xcccccccc
    s_mov_b32 s41, 0xcccccccc
    s_mov_b32 s42, 0xaaaaaaaa
    s_mov_b32 s43, 0xaaaaaaaa
    s_mov_b32 s45, 0x3db504f3
    v_and_b32 v33, 15, v0
    v_and_b32 v34, 1, v33
    v_lshlrev_b32 v34, 4, v34
    v_mov_b32 v8, 0xffff
    v_lshlrev_b32 v34, v34, v8
    v_lshrrev_b32 v33, 1, v33
    v_cmp_eq_u32 vcc, 0, v33
    s_nop 1
    v_cndmask_b32 v8, 0, v34, vcc
    v_cmp_eq_u32 vcc, 1, v33
    s_nop 1
    v_cndmask_b32 v9, 0, v34, vcc
    v_cmp_eq_u32 vcc, 2, v33
    s_nop 1
    v_cndmask_b32 v10, 0, v34, vcc
    v_cmp_eq_u32 vcc, 3, v33
    s_nop 1
    v_cndmask_b32 v11, 0, v34, vcc
    v_lshlrev_b32 v2, 2, v0
    s_lshl_b32 s46, s38, 12
    s_add_u32 s46, s46, 8192
    v_add_u32 v2, s46, v2
    v_mov_b32 v35, 0xff800000
    v_mov_b32 v36, 0
    v_mov_b32 v20, 0
    v_mov_b32 v21, 0
    v_mov_b32 v22, 0
    v_mov_b32 v23, 0
    v_and_b32 v33, 15, v0
    v_lshlrev_b32 v33, 5, v33
    s_waitcnt vmcnt(5)
    buffer_load_dwordx4 v[88:91], v1, s[52:55], s72 offen offset:2048 nt
    s_waitcnt vmcnt(5)
    buffer_load_dwordx4 v[92:95], v1, s[52:55], s72 offen offset:3072 nt
    s_add_u32 s72, s72, 16384
    s_waitcnt vmcnt(5)
    buffer_load_dwordx4 v[96:99], v1, s[52:55], s72 offen offset:0 nt
    s_waitcnt vmcnt(5)
    buffer_load_dwordx4 v[100:103], v1, s[52:55], s72 offen offset:1024 nt
    s_waitcnt vmcnt(5)
    buffer_load_dwordx4 v[104:107], v1, s[52:55], s72 offen offset:2048 nt
    s_waitcnt vmcnt(5)
    buffer_load_dwordx4 v[108:111], v1, s[52:55], s72 offen offset:3072 nt
    s_add_u32 s72, s72, 16384
    s_waitcnt vmcnt(5)
    buffer_load_dwordx4 v[112:115], v1, s[52:55], s72 offen offset:0 nt
    s_waitcnt vmcnt(5)
    buffer_load_dwordx4 v[116:119], v1, s[52:55], s72 offen offset:1024 nt
    s_waitcnt vmcnt(5)
    buffer_load_dwordx4 v[120:123], v1, s[52:55], s72 offen offset:2048 nt
    s_waitcnt vmcnt(5)
    buffer_load_dwordx4 v[124:127], v1, s[52:55], s72 offen offset:3072 nt
    s_add_u32 s72, s72, 16384
    s_waitcnt vmcnt(5)
    buffer_load_dwordx4 v[128:131], v1, s[52:55], s72 offen offset:0 nt
    s_waitcnt vmcnt(5)
    buffer_load_dwordx4 v[132:135], v1, s[52:55], s72 offen offset:1024 nt
    s_waitcnt vmcnt(5)
    buffer_load_dwordx4 v[136:139], v1, s[52:55], s72 offen offset:2048 nt
    s_waitcnt vmcnt(5)
    buffer_load_dwordx4 v[140:143], v1, s[52:55], s72 offen offset:3072 nt
    s_add_u32 s72, s72, 16384
    s_waitcnt vmcnt(5)
    buffer_load_dwordx4 v[144:147], v1, s[52:55], s72 offen offset:0 nt
    s_waitcnt vmcnt(5)
    buffer_load_dwordx4 v[148:151], v1, s[52:55], s72 offen offset:1024 nt
    s_waitcnt vmcnt(5)
    buffer_load_dwordx4 v[152:155], v1, s[52:55], s72 offen offset:2048 nt
    s_waitcnt vmcnt(5)
    buffer_load_dwordx4 v[156:159], v1, s[52:55], s72 offen offset:3072 nt
    s_add_u32 s72, s72, 16384
    s_waitcnt vmcnt(5)
    buffer_load_dwordx4 v[160:163], v1, s[52:55], s72 offen offset:0 nt
    s_waitcnt vmcnt(5)
    buffer_load_dwordx4 v[164:167], v1, s[52:55], s72 offen offset:1024 nt
    s_waitcnt vmcnt(5)
    buffer_load_dwordx4 v[168:171], v1, s[52:55], s72 offen offset:2048 nt
    s_waitcnt vmcnt(5)
    buffer_load_dwordx4 v[172:175], v1, s[52:55], s72 offen offset:3072 nt
    s_add_u32 s72, s72, 16384
    s_waitcnt vmcnt(5)
    buffer_load_dwordx4 v[176:179], v1, s[52:55], s72 offen offset:0 nt
    s_waitcnt vmcnt(5)
    buffer_load_dwordx4 v[180:183], v1, s[52:55], s72 offen offset:1024 nt
    s_waitcnt vmcnt(5)
    buffer_load_dwordx4 v[184:187], v1, s[52:55], s72 offen offset:2048 nt
    s_waitcnt vmcnt(5)
    buffer_load_dwordx4 v[188:191], v1, s[52:55], s72 offen offset:3072 nt
    s_add_u32 s72, s72, 16384
    s_waitcnt vmcnt(5)
    buffer_load_dwordx4 v[192:195], v1, s[52:55], s72 offen offset:0 nt
    s_waitcnt vmcnt(5)
    buffer_load_dwordx4 v[196:199], v1, s[52:55], s72 offen offset:1024 nt
    s_waitcnt vmcnt(5)
    buffer_load_dwordx4 v[200:203], v1, s[52:55], s72 offen offset:2048 nt
    s_waitcnt vmcnt(5)
    buffer_load_dwordx4 v[204:207], v1, s[52:55], s72 offen offset:3072 nt
    s_add_u32 s72, s72, 16384
    s_waitcnt vmcnt(5)
    buffer_load_dwordx4 v[208:211], v1, s[52:55], s72 offen offset:0 nt
    s_waitcnt vmcnt(5)
    buffer_load_dwordx4 v[212:215], v1, s[52:55], s72 offen offset:1024 nt
    s_waitcnt vmcnt(5)
    buffer_load_dwordx4 v[216:219], v1, s[52:55], s72 offen offset:2048 nt
    s_waitcnt vmcnt(5)
    buffer_load_dwordx4 v[220:223], v1, s[52:55], s72 offen offset:3072 nt
    s_add_u32 s72, s72, 16384
    s_waitcnt vmcnt(5)
    buffer_load_dwordx4 v[224:227], v1, s[52:55], s72 offen offset:0 nt
    s_waitcnt vmcnt(5)
    buffer_load_dwordx4 v[228:231], v1, s[52:55], s72 offen offset:1024 nt
    s_waitcnt vmcnt(5)
    buffer_load_dwordx4 v[232:235], v1, s[52:55], s72 offen offset:2048 nt
    s_waitcnt vmcnt(5)
    buffer_load_dwordx4 v[236:239], v1, s[52:55], s72 offen offset:3072 nt
    s_add_u32 s72, s72, 16384
    s_waitcnt vmcnt(5)
    buffer_load_dwordx4 v[240:243], v1, s[52:55], s72 offen offset:0 nt
    s_waitcnt vmcnt(5)
    buffer_load_dwordx4 v[244:247], v1, s[52:55], s72 offen offset:1024 nt
    s_waitcnt vmcnt(5)
    buffer_load_dwordx4 v[248:251], v1, s[52:55], s72 offen offset:2048 nt
    s_waitcnt vmcnt(5)
    buffer_load_dwordx4 v[252:255], v1, s[52:55], s72 offen offset:3072 nt
    s_add_u32 s72, s72, 16384
    s_barrier
    ds_read_b128 v[44:47], v33 offset:0
    ds_read_b128 v[48:51], v33 offset:16
    ds_read_b128 v[52:55], v33 offset:512
    ds_read_b128 v[56:59], v33 offset:528
    ds_read_b128 v[24:27], v33 offset:1024
    ds_read_b128 v[28:31], v33 offset:1040
    ds_read_b128 v[12:15], v33 offset:1536
    ds_read_b128 v[16:19], v33 offset:1552
    s_waitcnt lgkmcnt(4)
    v_add_f32 v44, v44, v52
    v_add_f32 v45, v45, v53
    v_add_f32 v46, v46, v54
    v_add_f32 v47, v47, v55
    v_add_f32 v48, v48, v56
    v_add_f32 v49, v49, v57
    v_add_f32 v50, v50, v58
    v_add_f32 v51, v51, v59
    s_waitcnt lgkmcnt(0)
    v_add_f32 v24, v24, v12
    v_add_f32 v25, v25, v13
    v_add_f32 v26, v26, v14
    v_add_f32 v27, v27, v15
    v_add_f32 v28, v28, v16
    v_add_f32 v29, v29, v17
    v_add_f32 v30, v30, v18
    v_add_f32 v31, v31, v19
    v_add_f32 v44, v44, v24
    v_add_f32 v45, v45, v25
    v_add_f32 v46, v46, v26
    v_add_f32 v47, v47, v27
    v_add_f32 v48, v48, v28
    v_add_f32 v49, v49, v29
    v_add_f32 v50, v50, v30
    v_add_f32 v51, v51, v31
    v_cvt_pk_bf16_f32 v4, v44, v45
    v_cvt_pk_bf16_f32 v5, v46, v47
    v_cvt_pk_bf16_f32 v6, v48, v49
    v_cvt_pk_bf16_f32 v7, v50, v51
    v_dot2_f32_bf16 v24, v64, v4, 0
    v_dot2_f32_bf16 v25, v68, v4, 0
    v_dot2_f32_bf16 v24, v65, v5, v24
    v_dot2_f32_bf16 v25, v69, v5, v25
    v_dot2_f32_bf16 v24, v66, v6, v24
    v_dot2_f32_bf16 v25, v70, v6, v25
    v_dot2_f32_bf16 v24, v67, v7, v24
    v_dot2_f32_bf16 v25, v71, v7, v25
    s_waitcnt vmcnt(4)
    buffer_load_dwordx4 v[64:67], v1, s[52:55], s72 offen offset:0 nt
    v_add_f32_dpp v26, v24, v24 row_ror:8 row_mask:0xf bank_mask:0x3
    s_nop 1
    v_add_f32_dpp v26, v25, v25 row_ror:8 row_mask:0xf bank_mask:0xc
    s_waitcnt vmcnt(4)
    buffer_load_dwordx4 v[68:71], v1, s[52:55], s72 offen offset:1024 nt
    v_dot2_f32_bf16 v24, v72, v4, 0
    v_dot2_f32_bf16 v25, v76, v4, 0
    v_dot2_f32_bf16 v24, v73, v5, v24
    v_dot2_f32_bf16 v25, v77, v5, v25
    v_dot2_f32_bf16 v24, v74, v6, v24
    v_dot2_f32_bf16 v25, v78, v6, v25
    v_dot2_f32_bf16 v24, v75, v7, v24
    v_dot2_f32_bf16 v25, v79, v7, v25
    s_waitcnt vmcnt(4)
    buffer_load_dwordx4 v[72:75], v1, s[52:55], s72 offen offset:2048 nt
    v_add_f32_dpp v27, v24, v24 row_ror:8 row_mask:0xf bank_mask:0x3
    s_nop 1
    v_add_f32_dpp v27, v25, v25 row_ror:8 row_mask:0xf bank_mask:0xc
    v_add_f32_dpp v28, v26, v26 row_ror:12 row_mask:0xf bank_mask:0x5
    s_nop 1
    v_add_f32_dpp v28, v27, v27 row_ror:4 row_mask:0xf bank_mask:0xa
    s_waitcnt vmcnt(4)
    buffer_load_dwordx4 v[76:79], v1, s[52:55], s72 offen offset:3072 nt
    s_add_u32 s72, s72, 16384
    v_dot2_f32_bf16 v24, v80, v4, 0
    v_dot2_f32_bf16 v25, v84, v4, 0
    v_dot2_f32_bf16 v24, v81, v5, v24
    v_dot2_f32_bf16 v25, v85, v5, v25
    v_dot2_f32_bf16 v24, v82, v6, v24
    v_dot2_f32_bf16 v25, v86, v6, v25
    v_dot2_f32_bf16 v24, v83, v7, v24
    v_dot2_f32_bf16 v25, v87, v7, v25
    s_waitcnt vmcnt(4)
    buffer_load_dwordx4 v[80:83], v1, s[52:55], s72 offen offset:0 nt
    v_add_f32_dpp v26, v24, v24 row_ror:8 row_mask:0xf bank_mask:0x3
    s_nop 1
    v_add_f32_dpp v26, v25, v25 row_ror:8 row_mask:0xf bank_mask:0xc
    v_dot2_f32_bf16 v24, v88, v4, 0
    v_dot2_f32_bf16 v25, v92, v4, 0
    v_dot2_f32_bf16 v24, v89, v5, v24
    v_dot2_f32_bf16 v25, v93, v5, v25
    v_dot2_f32_bf16 v24, v90, v6, v24
    v_dot2_f32_bf16 v25, v94, v6, v25
    v_dot2_f32_bf16 v24, v91, v7, v24
    v_dot2_f32_bf16 v25, v95, v7, v25
    s_nop 1
    v_add_f32_dpp v27, v24, v24 row_ror:8 row_mask:0xf bank_mask:0x3
    s_nop 1
    v_add_f32_dpp v27, v25, v25 row_ror:8 row_mask:0xf bank_mask:0xc
    v_add_f32_dpp v29, v26, v26 row_ror:12 row_mask:0xf bank_mask:0x5
    s_nop 1
    v_add_f32_dpp v29, v27, v27 row_ror:4 row_mask:0xf bank_mask:0xa
    v_cndmask_b32 v33, v28, v29, s[40:41]
    v_cndmask_b32 v34, v29, v28, s[40:41]
    s_nop 1
    v_add_f32_dpp v30, v34, v33 quad_perm:[2,3,0,1] row_mask:0xf bank_mask:0xf
    v_dot2_f32_bf16 v24, v96, v4, 0
    v_dot2_f32_bf16 v25, v100, v4, 0
    v_dot2_f32_bf16 v24, v97, v5, v24
    v_dot2_f32_bf16 v25, v101, v5, v25
    v_dot2_f32_bf16 v24, v98, v6, v24
    v_dot2_f32_bf16 v25, v102, v6, v25
    v_dot2_f32_bf16 v24, v99, v7, v24
    v_dot2_f32_bf16 v25, v103, v7, v25
    s_nop 1
    v_add_f32_dpp v26, v24, v24 row_ror:8 row_mask:0xf bank_mask:0x3
    s_nop 1
    v_add_f32_dpp v26, v25, v25 row_ror:8 row_mask:0xf bank_mask:0xc
    v_dot2_f32_bf16 v24, v104, v4, 0
    v_dot2_f32_bf16 v25, v108, v4, 0
    v_dot2_f32_bf16 v24, v105, v5, v24
    v_dot2_f32_bf16 v25, v109, v5, v25
    v_dot2_f32_bf16 v24, v106, v6, v24
    v_dot2_f32_bf16 v25, v110, v6, v25
    v_dot2_f32_bf16 v24, v107, v7, v24
    v_dot2_f32_bf16 v25, v111, v7, v25
    s_nop 1
    v_add_f32_dpp v27, v24, v24 row_ror:8 row_mask:0xf bank_mask:0x3
    s_nop 1
    v_add_f32_dpp v27, v25, v25 row_ror:8 row_mask:0xf bank_mask:0xc
    v_add_f32_dpp v28, v26, v26 row_ror:12 row_mask:0xf bank_mask:0x5
    s_nop 1
    v_add_f32_dpp v28, v27, v27 row_ror:4 row_mask:0xf bank_mask:0xa
    v_dot2_f32_bf16 v24, v112, v4, 0
    v_dot2_f32_bf16 v25, v116, v4, 0
    v_dot2_f32_bf16 v24, v113, v5, v24
    v_dot2_f32_bf16 v25, v117, v5, v25
    v_dot2_f32_bf16 v24, v114, v6, v24
    v_dot2_f32_bf16 v25, v118, v6, v25
    v_dot2_f32_bf16 v24, v115, v7, v24
    v_dot2_f32_bf16 v25, v119, v7, v25
    s_nop 1
    v_add_f32_dpp v26, v24, v24 row_ror:8 row_mask:0xf bank_mask:0x3
    s_nop 1
    v_add_f32_dpp v26, v25, v25 row_ror:8 row_mask:0xf bank_mask:0xc
    v_dot2_f32_bf16 v24, v120, v4, 0
    v_dot2_f32_bf16 v25, v124, v4, 0
    v_dot2_f32_bf16 v24, v121, v5, v24
    v_dot2_f32_bf16 v25, v125, v5, v25
    v_dot2_f32_bf16 v24, v122, v6, v24
    v_dot2_f32_bf16 v25, v126, v6, v25
    v_dot2_f32_bf16 v24, v123, v7, v24
    v_dot2_f32_bf16 v25, v127, v7, v25
    s_nop 1
    v_add_f32_dpp v27, v24, v24 row_ror:8 row_mask:0xf bank_mask:0x3
    s_nop 1
    v_add_f32_dpp v27, v25, v25 row_ror:8 row_mask:0xf bank_mask:0xc
    v_add_f32_dpp v29, v26, v26 row_ror:12 row_mask:0xf bank_mask:0x5
    s_nop 1
    v_add_f32_dpp v29, v27, v27 row_ror:4 row_mask:0xf bank_mask:0xa
    v_cndmask_b32 v33, v28, v29, s[40:41]
    v_cndmask_b32 v34, v29, v28, s[40:41]
    s_nop 1
    v_add_f32_dpp v31, v34, v33 quad_perm:[2,3,0,1] row_mask:0xf bank_mask:0xf
    v_cndmask_b32 v33, v30, v31, s[42:43]
    v_cndmask_b32 v34, v31, v30, s[42:43]
    s_nop 1
    v_add_f32_dpp v32, v34, v33 quad_perm:[1,0,3,2] row_mask:0xf bank_mask:0xf
    v_cvt_pk_bf16_f32 v32, v32, v32
    v_and_b32 v32, s39, v32
    v_mul_f32 v32, s45, v32
    v_cvt_pk_bf16_f32 v32, v32, v32
    v_and_b32 v32, s39, v32
    v_max_f32 v35, v35, v32
    ds_write_b32 v2, v32
    v_add_u32 v2, 0x100, v2
    v_dot2_f32_bf16 v24, v128, v4, 0
    v_dot2_f32_bf16 v25, v132, v4, 0
    v_dot2_f32_bf16 v24, v129, v5, v24
    v_dot2_f32_bf16 v25, v133, v5, v25
    v_dot2_f32_bf16 v24, v130, v6, v24
    v_dot2_f32_bf16 v25, v134, v6, v25
    v_dot2_f32_bf16 v24, v131, v7, v24
    v_dot2_f32_bf16 v25, v135, v7, v25
    s_nop 1
    v_add_f32_dpp v26, v24, v24 row_ror:8 row_mask:0xf bank_mask:0x3
    s_nop 1
    v_add_f32_dpp v26, v25, v25 row_ror:8 row_mask:0xf bank_mask:0xc
    v_dot2_f32_bf16 v24, v136, v4, 0
    v_dot2_f32_bf16 v25, v140, v4, 0
    v_dot2_f32_bf16 v24, v137, v5, v24
    v_dot2_f32_bf16 v25, v141, v5, v25
    v_dot2_f32_bf16 v24, v138, v6, v24
    v_dot2_f32_bf16 v25, v142, v6, v25
    v_dot2_f32_bf16 v24, v139, v7, v24
    v_dot2_f32_bf16 v25, v143, v7, v25
    s_nop 1
    v_add_f32_dpp v27, v24, v24 row_ror:8 row_mask:0xf bank_mask:0x3
    s_nop 1
    v_add_f32_dpp v27, v25, v25 row_ror:8 row_mask:0xf bank_mask:0xc
    v_add_f32_dpp v28, v26, v26 row_ror:12 row_mask:0xf bank_mask:0x5
    s_nop 1
    v_add_f32_dpp v28, v27, v27 row_ror:4 row_mask:0xf bank_mask:0xa
    v_dot2_f32_bf16 v24, v144, v4, 0
    v_dot2_f32_bf16 v25, v148, v4, 0
    v_dot2_f32_bf16 v24, v145, v5, v24
    v_dot2_f32_bf16 v25, v149, v5, v25
    v_dot2_f32_bf16 v24, v146, v6, v24
    v_dot2_f32_bf16 v25, v150, v6, v25
    v_dot2_f32_bf16 v24, v147, v7, v24
    v_dot2_f32_bf16 v25, v151, v7, v25
    s_nop 1
    v_add_f32_dpp v26, v24, v24 row_ror:8 row_mask:0xf bank_mask:0x3
    s_nop 1
    v_add_f32_dpp v26, v25, v25 row_ror:8 row_mask:0xf bank_mask:0xc
    v_dot2_f32_bf16 v24, v152, v4, 0
    v_dot2_f32_bf16 v25, v156, v4, 0
    v_dot2_f32_bf16 v24, v153, v5, v24
    v_dot2_f32_bf16 v25, v157, v5, v25
    v_dot2_f32_bf16 v24, v154, v6, v24
    v_dot2_f32_bf16 v25, v158, v6, v25
    v_dot2_f32_bf16 v24, v155, v7, v24
    v_dot2_f32_bf16 v25, v159, v7, v25
    s_nop 1
    v_add_f32_dpp v27, v24, v24 row_ror:8 row_mask:0xf bank_mask:0x3
    s_nop 1
    v_add_f32_dpp v27, v25, v25 row_ror:8 row_mask:0xf bank_mask:0xc
    v_add_f32_dpp v29, v26, v26 row_ror:12 row_mask:0xf bank_mask:0x5
    s_nop 1
    v_add_f32_dpp v29, v27, v27 row_ror:4 row_mask:0xf bank_mask:0xa
    v_cndmask_b32 v33, v28, v29, s[40:41]
    v_cndmask_b32 v34, v29, v28, s[40:41]
    s_nop 1
    v_add_f32_dpp v30, v34, v33 quad_perm:[2,3,0,1] row_mask:0xf bank_mask:0xf
    v_dot2_f32_bf16 v24, v160, v4, 0
    v_dot2_f32_bf16 v25, v164, v4, 0
    v_dot2_f32_bf16 v24, v161, v5, v24
    v_dot2_f32_bf16 v25, v165, v5, v25
    v_dot2_f32_bf16 v24, v162, v6, v24
    v_dot2_f32_bf16 v25, v166, v6, v25
    v_dot2_f32_bf16 v24, v163, v7, v24
    v_dot2_f32_bf16 v25, v167, v7, v25
    s_nop 1
    v_add_f32_dpp v26, v24, v24 row_ror:8 row_mask:0xf bank_mask:0x3
    s_nop 1
    v_add_f32_dpp v26, v25, v25 row_ror:8 row_mask:0xf bank_mask:0xc
    v_dot2_f32_bf16 v24, v168, v4, 0
    v_dot2_f32_bf16 v25, v172, v4, 0
    v_dot2_f32_bf16 v24, v169, v5, v24
    v_dot2_f32_bf16 v25, v173, v5, v25
    v_dot2_f32_bf16 v24, v170, v6, v24
    v_dot2_f32_bf16 v25, v174, v6, v25
    v_dot2_f32_bf16 v24, v171, v7, v24
    v_dot2_f32_bf16 v25, v175, v7, v25
    s_nop 1
    v_add_f32_dpp v27, v24, v24 row_ror:8 row_mask:0xf bank_mask:0x3
    s_nop 1
    v_add_f32_dpp v27, v25, v25 row_ror:8 row_mask:0xf bank_mask:0xc
    v_add_f32_dpp v28, v26, v26 row_ror:12 row_mask:0xf bank_mask:0x5
    s_nop 1
    v_add_f32_dpp v28, v27, v27 row_ror:4 row_mask:0xf bank_mask:0xa
    v_dot2_f32_bf16 v24, v176, v4, 0
    v_dot2_f32_bf16 v25, v180, v4, 0
    v_dot2_f32_bf16 v24, v177, v5, v24
    v_dot2_f32_bf16 v25, v181, v5, v25
    v_dot2_f32_bf16 v24, v178, v6, v24
    v_dot2_f32_bf16 v25, v182, v6, v25
    v_dot2_f32_bf16 v24, v179, v7, v24
    v_dot2_f32_bf16 v25, v183, v7, v25
    s_nop 1
    v_add_f32_dpp v26, v24, v24 row_ror:8 row_mask:0xf bank_mask:0x3
    s_nop 1
    v_add_f32_dpp v26, v25, v25 row_ror:8 row_mask:0xf bank_mask:0xc
    v_dot2_f32_bf16 v24, v184, v4, 0
    v_dot2_f32_bf16 v25, v188, v4, 0
    v_dot2_f32_bf16 v24, v185, v5, v24
    v_dot2_f32_bf16 v25, v189, v5, v25
    v_dot2_f32_bf16 v24, v186, v6, v24
    v_dot2_f32_bf16 v25, v190, v6, v25
    v_dot2_f32_bf16 v24, v187, v7, v24
    v_dot2_f32_bf16 v25, v191, v7, v25
    s_nop 1
    v_add_f32_dpp v27, v24, v24 row_ror:8 row_mask:0xf bank_mask:0x3
    s_nop 1
    v_add_f32_dpp v27, v25, v25 row_ror:8 row_mask:0xf bank_mask:0xc
    v_add_f32_dpp v29, v26, v26 row_ror:12 row_mask:0xf bank_mask:0x5
    s_nop 1
    v_add_f32_dpp v29, v27, v27 row_ror:4 row_mask:0xf bank_mask:0xa
    v_cndmask_b32 v33, v28, v29, s[40:41]
    v_cndmask_b32 v34, v29, v28, s[40:41]
    s_nop 1
    v_add_f32_dpp v31, v34, v33 quad_perm:[2,3,0,1] row_mask:0xf bank_mask:0xf
    v_cndmask_b32 v33, v30, v31, s[42:43]
    v_cndmask_b32 v34, v31, v30, s[42:43]
    s_nop 1
    v_add_f32_dpp v32, v34, v33 quad_perm:[1,0,3,2] row_mask:0xf bank_mask:0xf
    v_cvt_pk_bf16_f32 v32, v32, v32
    v_and_b32 v32, s39, v32
    v_mul_f32 v32, s45, v32
    v_cvt_pk_bf16_f32 v32, v32, v32
    v_and_b32 v32, s39, v32
    v_max_f32 v35, v35, v32
    ds_write_b32 v2, v32
    v_add_u32 v2, 0x100, v2
    v_dot2_f32_bf16 v24, v192, v4, 0
    v_dot2_f32_bf16 v25, v196, v4, 0
    v_dot2_f32_bf16 v24, v193, v5, v24
    v_dot2_f32_bf16 v25, v197, v5, v25
    v_dot2_f32_bf16 v24, v194, v6, v24
    v_dot2_f32_bf16 v25, v198, v6, v25
    v_dot2_f32_bf16 v24, v195, v7, v24
    v_dot2_f32_bf16 v25, v199, v7, v25
    s_nop 1
    v_add_f32_dpp v26, v24, v24 row_ror:8 row_mask:0xf bank_mask:0x3
    s_nop 1
    v_add_f32_dpp v26, v25, v25 row_ror:8 row_mask:0xf bank_mask:0xc
    v_dot2_f32_bf16 v24, v200, v4, 0
    v_dot2_f32_bf16 v25, v204, v4, 0
    v_dot2_f32_bf16 v24, v201, v5, v24
    v_dot2_f32_bf16 v25, v205, v5, v25
    v_dot2_f32_bf16 v24, v202, v6, v24
    v_dot2_f32_bf16 v25, v206, v6, v25
    v_dot2_f32_bf16 v24, v203, v7, v24
    v_dot2_f32_bf16 v25, v207, v7, v25
    s_nop 1
    v_add_f32_dpp v27, v24, v24 row_ror:8 row_mask:0xf bank_mask:0x3
    s_nop 1
    v_add_f32_dpp v27, v25, v25 row_ror:8 row_mask:0xf bank_mask:0xc
    v_add_f32_dpp v28, v26, v26 row_ror:12 row_mask:0xf bank_mask:0x5
    s_nop 1
    v_add_f32_dpp v28, v27, v27 row_ror:4 row_mask:0xf bank_mask:0xa
    v_dot2_f32_bf16 v24, v208, v4, 0
    v_dot2_f32_bf16 v25, v212, v4, 0
    v_dot2_f32_bf16 v24, v209, v5, v24
    v_dot2_f32_bf16 v25, v213, v5, v25
    v_dot2_f32_bf16 v24, v210, v6, v24
    v_dot2_f32_bf16 v25, v214, v6, v25
    v_dot2_f32_bf16 v24, v211, v7, v24
    v_dot2_f32_bf16 v25, v215, v7, v25
    s_nop 1
    v_add_f32_dpp v26, v24, v24 row_ror:8 row_mask:0xf bank_mask:0x3
    s_nop 1
    v_add_f32_dpp v26, v25, v25 row_ror:8 row_mask:0xf bank_mask:0xc
    v_dot2_f32_bf16 v24, v216, v4, 0
    v_dot2_f32_bf16 v25, v220, v4, 0
    v_dot2_f32_bf16 v24, v217, v5, v24
    v_dot2_f32_bf16 v25, v221, v5, v25
    v_dot2_f32_bf16 v24, v218, v6, v24
    v_dot2_f32_bf16 v25, v222, v6, v25
    v_dot2_f32_bf16 v24, v219, v7, v24
    v_dot2_f32_bf16 v25, v223, v7, v25
    s_nop 1
    v_add_f32_dpp v27, v24, v24 row_ror:8 row_mask:0xf bank_mask:0x3
    s_nop 1
    v_add_f32_dpp v27, v25, v25 row_ror:8 row_mask:0xf bank_mask:0xc
    v_add_f32_dpp v29, v26, v26 row_ror:12 row_mask:0xf bank_mask:0x5
    s_nop 1
    v_add_f32_dpp v29, v27, v27 row_ror:4 row_mask:0xf bank_mask:0xa
    v_cndmask_b32 v33, v28, v29, s[40:41]
    v_cndmask_b32 v34, v29, v28, s[40:41]
    s_nop 1
    v_add_f32_dpp v30, v34, v33 quad_perm:[2,3,0,1] row_mask:0xf bank_mask:0xf
    v_dot2_f32_bf16 v24, v224, v4, 0
    v_dot2_f32_bf16 v25, v228, v4, 0
    v_dot2_f32_bf16 v24, v225, v5, v24
    v_dot2_f32_bf16 v25, v229, v5, v25
    v_dot2_f32_bf16 v24, v226, v6, v24
    v_dot2_f32_bf16 v25, v230, v6, v25
    v_dot2_f32_bf16 v24, v227, v7, v24
    v_dot2_f32_bf16 v25, v231, v7, v25
    s_nop 1
    v_add_f32_dpp v26, v24, v24 row_ror:8 row_mask:0xf bank_mask:0x3
    s_nop 1
    v_add_f32_dpp v26, v25, v25 row_ror:8 row_mask:0xf bank_mask:0xc
    v_dot2_f32_bf16 v24, v232, v4, 0
    v_dot2_f32_bf16 v25, v236, v4, 0
    v_dot2_f32_bf16 v24, v233, v5, v24
    v_dot2_f32_bf16 v25, v237, v5, v25
    v_dot2_f32_bf16 v24, v234, v6, v24
    v_dot2_f32_bf16 v25, v238, v6, v25
    v_dot2_f32_bf16 v24, v235, v7, v24
    v_dot2_f32_bf16 v25, v239, v7, v25
    s_nop 1
    v_add_f32_dpp v27, v24, v24 row_ror:8 row_mask:0xf bank_mask:0x3
    s_nop 1
    v_add_f32_dpp v27, v25, v25 row_ror:8 row_mask:0xf bank_mask:0xc
    v_add_f32_dpp v28, v26, v26 row_ror:12 row_mask:0xf bank_mask:0x5
    s_nop 1
    v_add_f32_dpp v28, v27, v27 row_ror:4 row_mask:0xf bank_mask:0xa
    v_dot2_f32_bf16 v24, v240, v4, 0
    v_dot2_f32_bf16 v25, v244, v4, 0
    v_dot2_f32_bf16 v24, v241, v5, v24
    v_dot2_f32_bf16 v25, v245, v5, v25
    v_dot2_f32_bf16 v24, v242, v6, v24
    v_dot2_f32_bf16 v25, v246, v6, v25
    v_dot2_f32_bf16 v24, v243, v7, v24
    v_dot2_f32_bf16 v25, v247, v7, v25
    s_nop 1
    v_add_f32_dpp v26, v24, v24 row_ror:8 row_mask:0xf bank_mask:0x3
    s_nop 1
    v_add_f32_dpp v26, v25, v25 row_ror:8 row_mask:0xf bank_mask:0xc
    v_dot2_f32_bf16 v24, v248, v4, 0
    v_dot2_f32_bf16 v25, v252, v4, 0
    v_dot2_f32_bf16 v24, v249, v5, v24
    v_dot2_f32_bf16 v25, v253, v5, v25
    v_dot2_f32_bf16 v24, v250, v6, v24
    v_dot2_f32_bf16 v25, v254, v6, v25
    v_dot2_f32_bf16 v24, v251, v7, v24
    v_dot2_f32_bf16 v25, v255, v7, v25
    s_nop 1
    v_add_f32_dpp v27, v24, v24 row_ror:8 row_mask:0xf bank_mask:0x3
    s_nop 1
    v_add_f32_dpp v27, v25, v25 row_ror:8 row_mask:0xf bank_mask:0xc
    v_add_f32_dpp v29, v26, v26 row_ror:12 row_mask:0xf bank_mask:0x5
    s_nop 1
    v_add_f32_dpp v29, v27, v27 row_ror:4 row_mask:0xf bank_mask:0xa
    v_cndmask_b32 v33, v28, v29, s[40:41]
    v_cndmask_b32 v34, v29, v28, s[40:41]
    s_nop 1
    v_add_f32_dpp v31, v34, v33 quad_perm:[2,3,0,1] row_mask:0xf bank_mask:0xf
    v_cndmask_b32 v33, v30, v31, s[42:43]
    v_cndmask_b32 v34, v31, v30, s[42:43]
    s_nop 1
    v_add_f32_dpp v32, v34, v33 quad_perm:[1,0,3,2] row_mask:0xf bank_mask:0xf
    v_cvt_pk_bf16_f32 v32, v32, v32
    v_and_b32 v32, s39, v32
    v_mul_f32 v32, s45, v32
    v_cvt_pk_bf16_f32 v32, v32, v32
    v_and_b32 v32, s39, v32
    v_max_f32 v35, v35, v32
    ds_write_b32 v2, v32
    v_add_u32 v2, 0x100, v2
    s_mov_b32 s50, 12
L_kloop:
    s_waitcnt vmcnt(4)
    buffer_load_dwordx4 v[84:87], v1, s[52:55], s72 offen offset:1024 nt
    v_dot2_f32_bf16 v24, v64, v4, 0
    v_dot2_f32_bf16 v24, v65, v5, v24
    v_dot2_f32_bf16 v24, v66, v6, v24
    v_dot2_f32_bf16 v24, v67, v7, v24
    s_waitcnt vmcnt(4)
    buffer_load_dwordx4 v[88:91], v1, s[52:55], s72 offen offset:2048 nt
    v_dot2_f32_bf16 v25, v68, v4, 0
    v_dot2_f32_bf16 v25, v69, v5, v25
    v_dot2_f32_bf16 v25, v70, v6, v25
    v_dot2_f32_bf16 v25, v71, v7, v25
    v_add_f32_dpp v26, v24, v24 row_ror:8 row_mask:0xf bank_mask:0x3
    s_nop 1
    v_add_f32_dpp v26, v25, v25 row_ror:8 row_mask:0xf bank_mask:0xc
    s_waitcnt vmcnt(4)
    buffer_load_dwordx4 v[92:95], v1, s[52:55], s72 offen offset:3072 nt
    s_add_u32 s72, s72, 16384
    v_dot2_f32_bf16 v24, v72, v4, 0
    v_dot2_f32_bf16 v24, v73, v5, v24
    v_dot2_f32_bf16 v24, v74, v6, v24
    v_dot2_f32_bf16 v24, v75, v7, v24
    s_waitcnt vmcnt(4)
    buffer_load_dwordx4 v[96:99], v1, s[52:55], s72 offen offset:0 nt
    v_dot2_f32_bf16 v25, v76, v4, 0
    v_dot2_f32_bf16 v25, v77, v5, v25
    v_dot2_f32_bf16 v25, v78, v6, v25
    v_dot2_f32_bf16 v25, v79, v7, v25
    v_add_f32_dpp v27, v24, v24 row_ror:8 row_mask:0xf bank_mask:0x3
    s_nop 1
    v_add_f32_dpp v27, v25, v25 row_ror:8 row_mask:0xf bank_mask:0xc
    v_add_f32_dpp v28, v26, v26 row_ror:12 row_mask:0xf bank_mask:0x5
    s_nop 1
    v_add_f32_dpp v28, v27, v27 row_ror:4 row_mask:0xf bank_mask:0xa
    s_waitcnt vmcnt(4)
    buffer_load_dwordx4 v[100:103], v1, s[52:55], s72 offen offset:1024 nt
    v_dot2_f32_bf16 v24, v80, v4, 0
    v_dot2_f32_bf16 v24, v81, v5, v24
    v_dot2_f32_bf16 v24, v82, v6, v24
    v_dot2_f32_bf16 v24, v83, v7, v24
    s_waitcnt vmcnt(4)
    buffer_load_dwordx4 v[104:107], v1, s[52:55], s72 offen offset:2048 nt
    v_dot2_f32_bf16 v25, v84, v4, 0
    v_dot2_f32_bf16 v25, v85, v5, v25
    v_dot2_f32_bf16 v25, v86, v6, v25
    v_dot2_f32_bf16 v25, v87, v7, v25
    v_add_f32_dpp v26, v24, v24 row_ror:8 row_mask:0xf bank_mask:0x3
    s_nop 1
    v_add_f32_dpp v26, v25, v25 row_ror:8 row_mask:0xf bank_mask:0xc
    s_waitcnt vmcnt(4)
    buffer_load_dwordx4 v[108:111], v1, s[52:55], s72 offen offset:3072 nt
    s_add_u32 s72, s72, 16384
    v_dot2_f32_bf16 v24, v88, v4, 0
    v_dot2_f32_bf16 v24, v89, v5, v24
    v_dot2_f32_bf16 v24, v90, v6, v24
    v_dot2_f32_bf16 v24, v91, v7, v24
    s_waitcnt vmcnt(4)
    buffer_load_dwordx4 v[112:115], v1, s[52:55], s72 offen offset:0 nt
    v_dot2_f32_bf16 v25, v92, v4, 0
    v_dot2_f32_bf16 v25, v93, v5, v25
    v_dot2_f32_bf16 v25, v94, v6, v25
    v_dot2_f32_bf16 v25, v95, v7, v25
    v_add_f32_dpp v27, v24, v24 row_ror:8 row_mask:0xf bank_mask:0x3
    s_nop 1
    v_add_f32_dpp v27, v25, v25 row_ror:8 row_mask:0xf bank_mask:0xc
    v_add_f32_dpp v29, v26, v26 row_ror:12 row_mask:0xf bank_mask:0x5
    s_nop 1
    v_add_f32_dpp v29, v27, v27 row_ror:4 row_mask:0xf bank_mask:0xa
    v_cndmask_b32 v33, v28, v29, s[40:41]
    v_cndmask_b32 v34, v29, v28, s[40:41]
    s_nop 1
    v_add_f32_dpp v30, v34, v33 quad_perm:[2,3,0,1] row_mask:0xf bank_mask:0xf
    s_waitcnt vmcnt(4)
    buffer_load_dwordx4 v[116:119], v1, s[52:55], s72 offen offset:1024 nt
    v_dot2_f32_bf16 v24, v96, v4, 0
    v_dot2_f32_bf16 v24, v97, v5, v24
    v_dot2_f32_bf16 v24, v98, v6, v24
    v_dot2_f32_bf16 v24, v99, v7, v24
    s_waitcnt vmcnt(4)
    buffer_load_dwordx4 v[120:123], v1, s[52:55], s72 offen offset:2048 nt
    v_dot2_f32_bf16 v25, v100, v4, 0
    v_dot2_f32_bf16 v25, v101, v5, v25
    v_dot2_f32_bf16 v25, v102, v6, v25
    v_dot2_f32_bf16 v25, v103, v7, v25
    v_add_f32_dpp v26, v24, v24 row_ror:8 row_mask:0xf bank_mask:0x3
    s_nop 1
    v_add_f32_dpp v26, v25, v25 row_ror:8 row_mask:0xf bank_mask:0xc
    s_waitcnt vmcnt(4)
    buffer_load_dwordx4 v[124:127], v1, s[52:55], s72 offen offset:3072 nt
    s_add_u32 s72, s72, 16384
    v_dot2_f32_bf16 v24, v104, v4, 0
    v_dot2_f32_bf16 v24, v105, v5, v24
    v_dot2_f32_bf16 v24, v106, v6, v24
    v_dot2_f32_bf16 v24, v107, v7, v24
    s_waitcnt vmcnt(4)
    buffer_load_dwordx4 v[64:67], v1, s[52:55], s72 offen offset:0 nt
    v_dot2_f32_bf16 v25, v108, v4, 0
    v_dot2_f32_bf16 v25, v109, v5, v25
    v_dot2_f32_bf16 v25, v110, v6, v25
    v_dot2_f32_bf16 v25, v111, v7, v25
    v_add_f32_dpp v27, v24, v24 row_ror:8 row_mask:0xf bank_mask:0x3
    s_nop 1
    v_add_f32_dpp v27, v25, v25 row_ror:8 row_mask:0xf bank_mask:0xc
    v_add_f32_dpp v28, v26, v26 row_ror:12 row_mask:0xf bank_mask:0x5
    s_nop 1
    v_add_f32_dpp v28, v27, v27 row_ror:4 row_mask:0xf bank_mask:0xa
    s_waitcnt vmcnt(4)
    buffer_load_dwordx4 v[68:71], v1, s[52:55], s72 offen offset:1024 nt
    v_dot2_f32_bf16 v24, v112, v4, 0
    v_dot2_f32_bf16 v24, v113, v5, v24
    v_dot2_f32_bf16 v24, v114, v6, v24
    v_dot2_f32_bf16 v24, v115, v7, v24
    s_waitcnt vmcnt(4)
    buffer_load_dwordx4 v[72:75], v1, s[52:55], s72 offen offset:2048 nt
    v_dot2_f32_bf16 v25, v116, v4, 0
    v_dot2_f32_bf16 v25, v117, v5, v25
    v_dot2_f32_bf16 v25, v118, v6, v25
    v_dot2_f32_bf16 v25, v119, v7, v25
    v_add_f32_dpp v26, v24, v24 row_ror:8 row_mask:0xf bank_mask:0x3
    s_nop 1
    v_add_f32_dpp v26, v25, v25 row_ror:8 row_mask:0xf bank_mask:0xc
    s_waitcnt vmcnt(4)
    buffer_load_dwordx4 v[76:79], v1, s[52:55], s72 offen offset:3072 nt
    s_add_u32 s72, s72, 16384
    v_dot2_f32_bf16 v24, v120, v4, 0
    v_dot2_f32_bf16 v24, v121, v5, v24
    v_dot2_f32_bf16 v24, v122, v6, v24
    v_dot2_f32_bf16 v24, v123, v7, v24
    s_waitcnt vmcnt(4)
    buffer_load_dwordx4 v[80:83], v1, s[52:55], s72 offen offset:0 nt
    v_dot2_f32_bf16 v25, v124, v4, 0
    v_dot2_f32_bf16 v25, v125, v5, v25
    v_dot2_f32_bf16 v25, v126, v6, v25
    v_dot2_f32_bf16 v25, v127, v7, v25
    v_add_f32_dpp v27, v24, v24 row_ror:8 row_mask:0xf bank_mask:0x3
    s_nop 1
    v_add_f32_dpp v27, v25, v25 row_ror:8 row_mask:0xf bank_mask:0xc
    v_add_f32_dpp v29, v26, v26 row_ror:12 row_mask:0xf bank_mask:0x5
    s_nop 1
    v_add_f32_dpp v29, v27, v27 row_ror:4 row_mask:0xf bank_mask:0xa
    v_cndmask_b32 v33, v28, v29, s[40:41]
    v_cndmask_b32 v34, v29, v28, s[40:41]
    s_nop 1
    v_add_f32_dpp v31, v34, v33 quad_perm:[2,3,0,1] row_mask:0xf bank_mask:0xf
    v_cndmask_b32 v33, v30, v31, s[42:43]
    v_cndmask_b32 v34, v31, v30, s[42:43]
    s_nop 1
    v_add_f32_dpp v32, v34, v33 quad_perm:[1,0,3,2] row_mask:0xf bank_mask:0xf
    v_cvt_pk_bf16_f32 v32, v32, v32
    v_and_b32 v32, s39, v32
    v_mul_f32 v32, s45, v32
    v_cvt_pk_bf16_f32 v32, v32, v32
    v_and_b32 v32, s39, v32
    v_max_f32 v35, v35, v32
    ds_write_b32 v2, v32
    v_add_u32 v2, 0x100, v2
    s_sub_u32 s50, s50, 1
    s_cmp_lg_u32 s50, 0
    s_cbranch_scc1 L_kloop
    s_waitcnt vmcnt(4)
    buffer_load_dwordx4 v[84:87], v1, s[52:55], s72 offen offset:1024 nt
    v_dot2_f32_bf16 v24, v64, v4, 0
    v_dot2_f32_bf16 v24, v65, v5, v24
    v_dot2_f32_bf16 v24, v66, v6, v24
    v_dot2_f32_bf16 v24, v67, v7, v24
    s_waitcnt vmcnt(4)
    buffer_load_dwordx4 v[88:91], v1, s[52:55], s72 offen offset:2048 nt
    v_dot2_f32_bf16 v25, v68, v4, 0
    v_dot2_f32_bf16 v25, v69, v5, v25
    v_dot2_f32_bf16 v25, v70, v6, v25
    v_dot2_f32_bf16 v25, v71, v7, v25
    v_add_f32_dpp v26, v24, v24 row_ror:8 row_mask:0xf bank_mask:0x3
    s_nop 1
    v_add_f32_dpp v26, v25, v25 row_ror:8 row_mask:0xf bank_mask:0xc
    s_waitcnt vmcnt(4)
    buffer_load_dwordx4 v[92:95], v1, s[52:55], s72 offen offset:3072 nt
    s_add_u32 s72, s72, 16384
    v_dot2_f32_bf16 v24, v72, v4, 0
    v_dot2_f32_bf16 v24, v73, v5, v24
    v_dot2_f32_bf16 v24, v74, v6, v24
    v_dot2_f32_bf16 v24, v75, v7, v24
    s_waitcnt vmcnt(4)
    buffer_load_dwordx4 v[96:99], v1, s[52:55], s72 offen offset:0 nt
    v_dot2_f32_bf16 v25, v76, v4, 0
    v_dot2_f32_bf16 v25, v77, v5, v25
    v_dot2_f32_bf16 v25, v78, v6, v25
    v_dot2_f32_bf16 v25, v79, v7, v25
    v_add_f32_dpp v27, v24, v24 row_ror:8 row_mask:0xf bank_mask:0x3
    s_nop 1
    v_add_f32_dpp v27, v25, v25 row_ror:8 row_mask:0xf bank_mask:0xc
    v_add_f32_dpp v28, v26, v26 row_ror:12 row_mask:0xf bank_mask:0x5
    s_nop 1
    v_add_f32_dpp v28, v27, v27 row_ror:4 row_mask:0xf bank_mask:0xa
    s_waitcnt vmcnt(4)
    buffer_load_dwordx4 v[100:103], v1, s[52:55], s72 offen offset:1024 nt
    v_dot2_f32_bf16 v24, v80, v4, 0
    v_dot2_f32_bf16 v24, v81, v5, v24
    v_dot2_f32_bf16 v24, v82, v6, v24
    v_dot2_f32_bf16 v24, v83, v7, v24
    s_waitcnt vmcnt(4)
    buffer_load_dwordx4 v[104:107], v1, s[52:55], s72 offen offset:2048 nt
    v_dot2_f32_bf16 v25, v84, v4, 0
    v_dot2_f32_bf16 v25, v85, v5, v25
    v_dot2_f32_bf16 v25, v86, v6, v25
    v_dot2_f32_bf16 v25, v87, v7, v25
    v_add_f32_dpp v26, v24, v24 row_ror:8 row_mask:0xf bank_mask:0x3
    s_nop 1
    v_add_f32_dpp v26, v25, v25 row_ror:8 row_mask:0xf bank_mask:0xc
    s_waitcnt vmcnt(4)
    buffer_load_dwordx4 v[108:111], v1, s[52:55], s72 offen offset:3072 nt
    s_add_u32 s72, s72, 16384
    v_dot2_f32_bf16 v24, v88, v4, 0
    v_dot2_f32_bf16 v24, v89, v5, v24
    v_dot2_f32_bf16 v24, v90, v6, v24
    v_dot2_f32_bf16 v24, v91, v7, v24
    s_waitcnt vmcnt(4)
    buffer_load_dwordx4 v[112:115], v1, s[52:55], s72 offen offset:0 nt
    v_dot2_f32_bf16 v25, v92, v4, 0
    v_dot2_f32_bf16 v25, v93, v5, v25
    v_dot2_f32_bf16 v25, v94, v6, v25
    v_dot2_f32_bf16 v25, v95, v7, v25
    v_add_f32_dpp v27, v24, v24 row_ror:8 row_mask:0xf bank_mask:0x3
    s_nop 1
    v_add_f32_dpp v27, v25, v25 row_ror:8 row_mask:0xf bank_mask:0xc
    v_add_f32_dpp v29, v26, v26 row_ror:12 row_mask:0xf bank_mask:0x5
    s_nop 1
    v_add_f32_dpp v29, v27, v27 row_ror:4 row_mask:0xf bank_mask:0xa
    v_cndmask_b32 v33, v28, v29, s[40:41]
    v_cndmask_b32 v34, v29, v28, s[40:41]
    s_nop 1
    v_add_f32_dpp v30, v34, v33 quad_perm:[2,3,0,1] row_mask:0xf bank_mask:0xf
    s_waitcnt vmcnt(4)
    buffer_load_dwordx4 v[116:119], v1, s[52:55], s72 offen offset:1024 nt
    v_dot2_f32_bf16 v24, v96, v4, 0
    v_dot2_f32_bf16 v24, v97, v5, v24
    v_dot2_f32_bf16 v24, v98, v6, v24
    v_dot2_f32_bf16 v24, v99, v7, v24
    s_waitcnt vmcnt(4)
    buffer_load_dwordx4 v[120:123], v1, s[52:55], s72 offen offset:2048 nt
    v_dot2_f32_bf16 v25, v100, v4, 0
    v_dot2_f32_bf16 v25, v101, v5, v25
    v_dot2_f32_bf16 v25, v102, v6, v25
    v_dot2_f32_bf16 v25, v103, v7, v25
    v_add_f32_dpp v26, v24, v24 row_ror:8 row_mask:0xf bank_mask:0x3
    s_nop 1
    v_add_f32_dpp v26, v25, v25 row_ror:8 row_mask:0xf bank_mask:0xc
    s_waitcnt vmcnt(4)
    buffer_load_dwordx4 v[124:127], v1, s[52:55], s72 offen offset:3072 nt
    s_add_u32 s72, s72, 16384
    v_dot2_f32_bf16 v24, v104, v4, 0
    v_dot2_f32_bf16 v24, v105, v5, v24
    v_dot2_f32_bf16 v24, v106, v6, v24
    v_dot2_f32_bf16 v24, v107, v7, v24
    s_waitcnt vmcnt(4)
    buffer_load_dwordx4 v[64:67], v1, s[56:59], s73 offen offset:0 nt
    v_dot2_f32_bf16 v25, v108, v4, 0
    v_dot2_f32_bf16 v25, v109, v5, v25
    v_dot2_f32_bf16 v25, v110, v6, v25
    v_dot2_f32_bf16 v25, v111, v7, v25
    v_add_f32_dpp v27, v24, v24 row_ror:8 row_mask:0xf bank_mask:0x3
    s_nop 1
    v_add_f32_dpp v27, v25, v25 row_ror:8 row_mask:0xf bank_mask:0xc
    v_add_f32_dpp v28, v26, v26 row_ror:12 row_mask:0xf bank_mask:0x5
    s_nop 1
    v_add_f32_dpp v28, v27, v27 row_ror:4 row_mask:0xf bank_mask:0xa
    s_waitcnt vmcnt(4)
    buffer_load_dwordx4 v[68:71], v1, s[56:59], s73 offen offset:1024 nt
    v_dot2_f32_bf16 v24, v112, v4, 0
    v_dot2_f32_bf16 v24, v113, v5, v24
    v_dot2_f32_bf16 v24, v114, v6, v24
    v_dot2_f32_bf16 v24, v115, v7, v24
    s_waitcnt vmcnt(4)
    buffer_load_dwordx4 v[72:75], v1, s[56:59], s73 offen offset:2048 nt
    v_dot2_f32_bf16 v25, v116, v4, 0
    v_dot2_f32_bf16 v25, v117, v5, v25
    v_dot2_f32_bf16 v25, v118, v6, v25
    v_dot2_f32_bf16 v25, v119, v7, v25
    v_add_f32_dpp v26, v24, v24 row_ror:8 row_mask:0xf bank_mask:0x3
    s_nop 1
    v_add_f32_dpp v26, v25, v25 row_ror:8 row_mask:0xf bank_mask:0xc
    s_waitcnt vmcnt(4)
    buffer_load_dwordx4 v[76:79], v1, s[56:59], s73 offen offset:3072 nt
    s_add_u32 s73, s73, 16384
    v_dot2_f32_bf16 v24, v120, v4, 0
    v_dot2_f32_bf16 v24, v121, v5, v24
    v_dot2_f32_bf16 v24, v122, v6, v24
    v_dot2_f32_bf16 v24, v123, v7, v24
    s_waitcnt vmcnt(4)
    buffer_load_dwordx4 v[80:83], v1, s[56:59], s73 offen offset:0 nt
    v_dot2_f32_bf16 v25, v124, v4, 0
    v_dot2_f32_bf16 v25, v125, v5, v25
    v_dot2_f32_bf16 v25, v126, v6, v25
    v_dot2_f32_bf16 v25, v127, v7, v25
    v_add_f32_dpp v27, v24, v24 row_ror:8 row_mask:0xf bank_mask:0x3
    s_nop 1
    v_add_f32_dpp v27, v25, v25 row_ror:8 row_mask:0xf bank_mask:0xc
    v_add_f32_dpp v29, v26, v26 row_ror:12 row_mask:0xf bank_mask:0x5
    s_nop 1
    v_add_f32_dpp v29, v27, v27 row_ror:4 row_mask:0xf bank_mask:0xa
    v_cndmask_b32 v33, v28, v29, s[40:41]
    v_cndmask_b32 v34, v29, v28, s[40:41]
    s_nop 1
    v_add_f32_dpp v31, v34, v33 quad_perm:[2,3,0,1] row_mask:0xf bank_mask:0xf
    v_cndmask_b32 v33, v30, v31, s[42:43]
    v_cndmask_b32 v34, v31, v30, s[42:43]
    s_nop 1
    v_add_f32_dpp v32, v34, v33 quad_perm:[1,0,3,2] row_mask:0xf bank_mask:0xf
    v_cvt_pk_bf16_f32 v32, v32, v32
    v_and_b32 v32, s39, v32
    v_mul_f32 v32, s45, v32
    v_cvt_pk_bf16_f32 v32, v32, v32
    v_and_b32 v32, s39, v32
    v_max_f32 v35, v35, v32
    ds_write_b32 v2, v32
    v_add_u32 v2, 0x100, v2
    v_max_f32_dpp v35, v35, v35 row_ror:8 row_mask:0xf bank_mask:0xf
    s_nop 1
    v_max_f32_dpp v35, v35, v35 row_ror:4 row_mask:0xf bank_mask:0xf
    s_nop 1
    v_max_f32_dpp v35, v35, v35 row_ror:2 row_mask:0xf bank_mask:0xf
    s_nop 1
    v_max_f32_dpp v35, v35, v35 row_ror:1 row_mask:0xf bank_mask:0xf
    v_mov_b32 v33, v35
    s_nop 1
    v_permlane16_swap_b32 v35, v33
    v_max_f32 v35, v35, v33
    v_mov_b32 v33, v35
    s_nop 1
    v_permlane32_swap_b32 v35, v33
    v_max_f32 v35, v35, v33
    v_add_u32 v2, 0xfffff000, v2
    s_waitcnt lgkmcnt(0)
    ds_read_b32 v38, v2
    s_waitcnt lgkmcnt(0)
    v_sub_f32 v33, v38, v35
    v_mul_f32 v33, s44, v33
    v_exp_f32 v33, v33
    s_nop 0
    v_add_f32 v36, v36, v33
    v_cvt_pk_bf16_f32 v37, v33, v33
    s_nop 1
    v_and_b32_dpp v12, v37, v8 row_newbcast:0 row_mask:0xf bank_mask:0xf
    v_and_b32_dpp v13, v37, v9 row_newbcast:0 row_mask:0xf bank_mask:0xf
    v_and_b32_dpp v14, v37, v10 row_newbcast:0 row_mask:0xf bank_mask:0xf
    v_and_b32_dpp v15, v37, v11 row_newbcast:0 row_mask:0xf bank_mask:0xf
    s_mov_b32 s50, 14
L_vloop:
    s_waitcnt vmcnt(4)
    buffer_load_dwordx4 v[84:87], v1, s[56:59], s73 offen offset:1024 nt
    v_mfma_f32_16x16x32_bf16 v[20:23], v[12:15], v[64:67], v[20:23]
    v_and_b32_dpp v16, v37, v8 row_newbcast:8 row_mask:0xf bank_mask:0xf
    v_and_b32_dpp v17, v37, v9 row_newbcast:8 row_mask:0xf bank_mask:0xf
    v_and_b32_dpp v18, v37, v10 row_newbcast:8 row_mask:0xf bank_mask:0xf
    v_and_b32_dpp v19, v37, v11 row_newbcast:8 row_mask:0xf bank_mask:0xf
    s_waitcnt vmcnt(4)
    buffer_load_dwordx4 v[88:91], v1, s[56:59], s73 offen offset:2048 nt
    v_mfma_f32_16x16x32_bf16 v[20:23], v[16:19], v[68:71], v[20:23]
    v_and_b32_dpp v12, v37, v8 row_newbcast:4 row_mask:0xf bank_mask:0xf
    v_and_b32_dpp v13, v37, v9 row_newbcast:4 row_mask:0xf bank_mask:0xf
    v_and_b32_dpp v14, v37, v10 row_newbcast:4 row_mask:0xf bank_mask:0xf
    v_and_b32_dpp v15, v37, v11 row_newbcast:4 row_mask:0xf bank_mask:0xf
    v_add_u32 v2, 0x100, v2
    ds_read_b32 v38, v2
    s_waitcnt vmcnt(4)
    buffer_load_dwordx4 v[92:95], v1, s[56:59], s73 offen offset:3072 nt
    s_add_u32 s73, s73, 16384
    v_mfma_f32_16x16x32_bf16 v[20:23], v[12:15], v[72:75], v[20:23]
    v_and_b32_dpp v16, v37, v8 row_newbcast:12 row_mask:0xf bank_mask:0xf
    v_and_b32_dpp v17, v37, v9 row_newbcast:12 row_mask:0xf bank_mask:0xf
    v_and_b32_dpp v18, v37, v10 row_newbcast:12 row_mask:0xf bank_mask:0xf
    v_and_b32_dpp v19, v37, v11 row_newbcast:12 row_mask:0xf bank_mask:0xf
    s_waitcnt vmcnt(4)
    buffer_load_dwordx4 v[96:99], v1, s[56:59], s73 offen offset:0 nt
    v_mfma_f32_16x16x32_bf16 v[20:23], v[16:19], v[76:79], v[20:23]
    v_and_b32_dpp v12, v37, v8 row_newbcast:2 row_mask:0xf bank_mask:0xf
    v_and_b32_dpp v13, v37, v9 row_newbcast:2 row_mask:0xf bank_mask:0xf
    v_and_b32_dpp v14, v37, v10 row_newbcast:2 row_mask:0xf bank_mask:0xf
    v_and_b32_dpp v15, v37, v11 row_newbcast:2 row_mask:0xf bank_mask:0xf
    s_waitcnt vmcnt(4)
    buffer_load_dwordx4 v[100:103], v1, s[56:59], s73 offen offset:1024 nt
    v_mfma_f32_16x16x32_bf16 v[20:23], v[12:15], v[80:83], v[20:23]
    v_and_b32_dpp v16, v37, v8 row_newbcast:10 row_mask:0xf bank_mask:0xf
    v_and_b32_dpp v17, v37, v9 row_newbcast:10 row_mask:0xf bank_mask:0xf
    v_and_b32_dpp v18, v37, v10 row_newbcast:10 row_mask:0xf bank_mask:0xf
    v_and_b32_dpp v19, v37, v11 row_newbcast:10 row_mask:0xf bank_mask:0xf
    s_waitcnt vmcnt(4)
    buffer_load_dwordx4 v[104:107], v1, s[56:59], s73 offen offset:2048 nt
    v_mfma_f32_16x16x32_bf16 v[20:23], v[16:19], v[84:87], v[20:23]
    v_and_b32_dpp v12, v37, v8 row_newbcast:6 row_mask:0xf bank_mask:0xf
    v_and_b32_dpp v13, v37, v9 row_newbcast:6 row_mask:0xf bank_mask:0xf
    v_and_b32_dpp v14, v37, v10 row_newbcast:6 row_mask:0xf bank_mask:0xf
    v_and_b32_dpp v15, v37, v11 row_newbcast:6 row_mask:0xf bank_mask:0xf
    s_waitcnt vmcnt(4)
    buffer_load_dwordx4 v[108:111], v1, s[56:59], s73 offen offset:3072 nt
    s_add_u32 s73, s73, 16384
    v_mfma_f32_16x16x32_bf16 v[20:23], v[12:15], v[88:91], v[20:23]
    v_and_b32_dpp v16, v37, v8 row_newbcast:14 row_mask:0xf bank_mask:0xf
    v_and_b32_dpp v17, v37, v9 row_newbcast:14 row_mask:0xf bank_mask:0xf
    v_and_b32_dpp v18, v37, v10 row_newbcast:14 row_mask:0xf bank_mask:0xf
    v_and_b32_dpp v19, v37, v11 row_newbcast:14 row_mask:0xf bank_mask:0xf
    s_waitcnt lgkmcnt(0)
    v_sub_f32 v33, v38, v35
    v_mul_f32 v33, s44, v33
    v_exp_f32 v33, v33
    s_nop 0
    v_add_f32 v36, v36, v33
    v_cvt_pk_bf16_f32 v39, v33, v33
    s_waitcnt vmcnt(4)
    buffer_load_dwordx4 v[112:115], v1, s[56:59], s73 offen offset:0 nt
    v_mfma_f32_16x16x32_bf16 v[20:23], v[16:19], v[92:95], v[20:23]
    v_and_b32_dpp v12, v37, v8 row_newbcast:1 row_mask:0xf bank_mask:0xf
    v_and_b32_dpp v13, v37, v9 row_newbcast:1 row_mask:0xf bank_mask:0xf
    v_and_b32_dpp v14, v37, v10 row_newbcast:1 row_mask:0xf bank_mask:0xf
    v_and_b32_dpp v15, v37, v11 row_newbcast:1 row_mask:0xf bank_mask:0xf
    s_waitcnt vmcnt(4)
    buffer_load_dwordx4 v[116:119], v1, s[56:59], s73 offen offset:1024 nt
    v_mfma_f32_16x16x32_bf16 v[20:23], v[12:15], v[96:99], v[20:23]
    v_and_b32_dpp v16, v37, v8 row_newbcast:9 row_mask:0xf bank_mask:0xf
    v_and_b32_dpp v17, v37, v9 row_newbcast:9 row_mask:0xf bank_mask:0xf
    v_and_b32_dpp v18, v37, v10 row_newbcast:9 row_mask:0xf bank_mask:0xf
    v_and_b32_dpp v19, v37, v11 row_newbcast:9 row_mask:0xf bank_mask:0xf
    s_waitcnt vmcnt(4)
    buffer_load_dwordx4 v[120:123], v1, s[56:59], s73 offen offset:2048 nt
    v_mfma_f32_16x16x32_bf16 v[20:23], v[16:19], v[100:103], v[20:23]
    v_and_b32_dpp v12, v37, v8 row_newbcast:5 row_mask:0xf bank_mask:0xf
    v_and_b32_dpp v13, v37, v9 row_newbcast:5 row_mask:0xf bank_mask:0xf
    v_and_b32_dpp v14, v37, v10 row_newbcast:5 row_mask:0xf bank_mask:0xf
    v_and_b32_dpp v15, v37, v11 row_newbcast:5 row_mask:0xf bank_mask:0xf
    s_waitcnt vmcnt(4)
    buffer_load_dwordx4 v[124:127], v1, s[56:59], s73 offen offset:3072 nt
    s_add_u32 s73, s73, 16384
    v_mfma_f32_16x16x32_bf16 v[20:23], v[12:15], v[104:107], v[20:23]
    v_and_b32_dpp v16, v37, v8 row_newbcast:13 row_mask:0xf bank_mask:0xf
    v_and_b32_dpp v17, v37, v9 row_newbcast:13 row_mask:0xf bank_mask:0xf
    v_and_b32_dpp v18, v37, v10 row_newbcast:13 row_mask:0xf bank_mask:0xf
    v_and_b32_dpp v19, v37, v11 row_newbcast:13 row_mask:0xf bank_mask:0xf
    s_waitcnt vmcnt(4)
    buffer_load_dwordx4 v[64:67], v1, s[56:59], s73 offen offset:0 nt
    v_mfma_f32_16x16x32_bf16 v[20:23], v[16:19], v[108:111], v[20:23]
    v_and_b32_dpp v12, v37, v8 row_newbcast:3 row_mask:0xf bank_mask:0xf
    v_and_b32_dpp v13, v37, v9 row_newbcast:3 row_mask:0xf bank_mask:0xf
    v_and_b32_dpp v14, v37, v10 row_newbcast:3 row_mask:0xf bank_mask:0xf
    v_and_b32_dpp v15, v37, v11 row_newbcast:3 row_mask:0xf bank_mask:0xf
    s_waitcnt vmcnt(4)
    buffer_load_dwordx4 v[68:71], v1, s[56:59], s73 offen offset:1024 nt
    v_mfma_f32_16x16x32_bf16 v[20:23], v[12:15], v[112:115], v[20:23]
    v_and_b32_dpp v16, v37, v8 row_newbcast:11 row_mask:0xf bank_mask:0xf
    v_and_b32_dpp v17, v37, v9 row_newbcast:11 row_mask:0xf bank_mask:0xf
    v_and_b32_dpp v18, v37, v10 row_newbcast:11 row_mask:0xf bank_mask:0xf
    v_and_b32_dpp v19, v37, v11 row_newbcast:11 row_mask:0xf bank_mask:0xf
    s_waitcnt vmcnt(4)
    buffer_load_dwordx4 v[72:75], v1, s[56:59], s73 offen offset:2048 nt
    v_mfma_f32_16x16x32_bf16 v[20:23], v[16:19], v[116:119], v[20:23]
    v_and_b32_dpp v12, v37, v8 row_newbcast:7 row_mask:0xf bank_mask:0xf
    v_and_b32_dpp v13, v37, v9 row_newbcast:7 row_mask:0xf bank_mask:0xf
    v_and_b32_dpp v14, v37, v10 row_newbcast:7 row_mask:0xf bank_mask:0xf
    v_and_b32_dpp v15, v37, v11 row_newbcast:7 row_mask:0xf bank_mask:0xf
    s_waitcnt vmcnt(4)
    buffer_load_dwordx4 v[76:79], v1, s[56:59], s73 offen offset:3072 nt
    s_add_u32 s73, s73, 16384
    v_mfma_f32_16x16x32_bf16 v[20:23], v[12:15], v[120:123], v[20:23]
    v_and_b32_dpp v16, v37, v8 row_newbcast:15 row_mask:0xf bank_mask:0xf
    v_and_b32_dpp v17, v37, v9 row_newbcast:15 row_mask:0xf bank_mask:0xf
    v_and_b32_dpp v18, v37, v10 row_newbcast:15 row_mask:0xf bank_mask:0xf
    v_and_b32_dpp v19, v37, v11 row_newbcast:15 row_mask:0xf bank_mask:0xf
    s_waitcnt vmcnt(4)
    buffer_load_dwordx4 v[80:83], v1, s[56:59], s73 offen offset:0 nt
    v_mfma_f32_16x16x32_bf16 v[20:23], v[16:19], v[124:127], v[20:23]
    v_and_b32_dpp v12, v39, v8 row_newbcast:0 row_mask:0xf bank_mask:0xf
    v_and_b32_dpp v13, v39, v9 row_newbcast:0 row_mask:0xf bank_mask:0xf
    v_and_b32_dpp v14, v39, v10 row_newbcast:0 row_mask:0xf bank_mask:0xf
    v_and_b32_dpp v15, v39, v11 row_newbcast:0 row_mask:0xf bank_mask:0xf
    v_mov_b32 v37, v39
    s_sub_u32 s50, s50, 1
    s_cmp_lg_u32 s50, 0
    s_cbranch_scc1 L_vloop
    buffer_load_dwordx4 v[84:87], v1, s[56:59], s73 offen offset:1024 nt
    buffer_load_dwordx4 v[88:91], v1, s[56:59], s73 offen offset:2048 nt
    buffer_load_dwordx4 v[92:95], v1, s[56:59], s73 offen offset:3072 nt
    s_add_u32 s73, s73, 16384
    s_waitcnt vmcnt(7)
    buffer_load_dwordx4 v[96:99], v1, s[56:59], s73 offen offset:0 nt
    v_mfma_f32_16x16x32_bf16 v[20:23], v[12:15], v[64:67], v[20:23]
    v_and_b32_dpp v16, v37, v8 row_newbcast:8 row_mask:0xf bank_mask:0xf
    v_and_b32_dpp v17, v37, v9 row_newbcast:8 row_mask:0xf bank_mask:0xf
    v_and_b32_dpp v18, v37, v10 row_newbcast:8 row_mask:0xf bank_mask:0xf
    v_and_b32_dpp v19, v37, v11 row_newbcast:8 row_mask:0xf bank_mask:0xf
    s_waitcnt vmcnt(7)
    buffer_load_dwordx4 v[100:103], v1, s[56:59], s73 offen offset:1024 nt
    v_mfma_f32_16x16x32_bf16 v[20:23], v[16:19], v[68:71], v[20:23]
    v_and_b32_dpp v12, v37, v8 row_newbcast:4 row_mask:0xf bank_mask:0xf
    v_and_b32_dpp v13, v37, v9 row_newbcast:4 row_mask:0xf bank_mask:0xf
    v_and_b32_dpp v14, v37, v10 row_newbcast:4 row_mask:0xf bank_mask:0xf
    v_and_b32_dpp v15, v37, v11 row_newbcast:4 row_mask:0xf bank_mask:0xf
    v_add_u32 v2, 0x100, v2
    ds_read_b32 v38, v2
    s_waitcnt vmcnt(7)
    buffer_load_dwordx4 v[104:107], v1, s[56:59], s73 offen offset:2048 nt
    v_mfma_f32_16x16x32_bf16 v[20:23], v[12:15], v[72:75], v[20:23]
    v_and_b32_dpp v16, v37, v8 row_newbcast:12 row_mask:0xf bank_mask:0xf
    v_and_b32_dpp v17, v37, v9 row_newbcast:12 row_mask:0xf bank_mask:0xf
    v_and_b32_dpp v18, v37, v10 row_newbcast:12 row_mask:0xf bank_mask:0xf
    v_and_b32_dpp v19, v37, v11 row_newbcast:12 row_mask:0xf bank_mask:0xf
    s_waitcnt vmcnt(7)
    buffer_load_dwordx4 v[108:111], v1, s[56:59], s73 offen offset:3072 nt
    s_add_u32 s73, s73, 16384
    v_mfma_f32_16x16x32_bf16 v[20:23], v[16:19], v[76:79], v[20:23]
    v_and_b32_dpp v12, v37, v8 row_newbcast:2 row_mask:0xf bank_mask:0xf
    v_and_b32_dpp v13, v37, v9 row_newbcast:2 row_mask:0xf bank_mask:0xf
    v_and_b32_dpp v14, v37, v10 row_newbcast:2 row_mask:0xf bank_mask:0xf
    v_and_b32_dpp v15, v37, v11 row_newbcast:2 row_mask:0xf bank_mask:0xf
    s_waitcnt vmcnt(7)
    buffer_load_dwordx4 v[112:115], v1, s[56:59], s73 offen offset:0 nt
    v_mfma_f32_16x16x32_bf16 v[20:23], v[12:15], v[80:83], v[20:23]
    v_and_b32_dpp v16, v37, v8 row_newbcast:10 row_mask:0xf bank_mask:0xf
    v_and_b32_dpp v17, v37, v9 row_newbcast:10 row_mask:0xf bank_mask:0xf
    v_and_b32_dpp v18, v37, v10 row_newbcast:10 row_mask:0xf bank_mask:0xf
    v_and_b32_dpp v19, v37, v11 row_newbcast:10 row_mask:0xf bank_mask:0xf
    s_waitcnt vmcnt(7)
    buffer_load_dwordx4 v[116:119], v1, s[56:59], s73 offen offset:1024 nt
    v_mfma_f32_16x16x32_bf16 v[20:23], v[16:19], v[84:87], v[20:23]
    v_and_b32_dpp v12, v37, v8 row_newbcast:6 row_mask:0xf bank_mask:0xf
    v_and_b32_dpp v13, v37, v9 row_newbcast:6 row_mask:0xf bank_mask:0xf
    v_and_b32_dpp v14, v37, v10 row_newbcast:6 row_mask:0xf bank_mask:0xf
    v_and_b32_dpp v15, v37, v11 row_newbcast:6 row_mask:0xf bank_mask:0xf
    s_waitcnt vmcnt(7)
    buffer_load_dwordx4 v[120:123], v1, s[56:59], s73 offen offset:2048 nt
    v_mfma_f32_16x16x32_bf16 v[20:23], v[12:15], v[88:91], v[20:23]
    v_and_b32_dpp v16, v37, v8 row_newbcast:14 row_mask:0xf bank_mask:0xf
    v_and_b32_dpp v17, v37, v9 row_newbcast:14 row_mask:0xf bank_mask:0xf
    v_and_b32_dpp v18, v37, v10 row_newbcast:14 row_mask:0xf bank_mask:0xf
    v_and_b32_dpp v19, v37, v11 row_newbcast:14 row_mask:0xf bank_mask:0xf
    s_waitcnt lgkmcnt(0)
    v_sub_f32 v33, v38, v35
    v_mul_f32 v33, s44, v33
    v_exp_f32 v33, v33
    s_nop 0
    v_add_f32 v36, v36, v33
    v_cvt_pk_bf16_f32 v39, v33, v33
    s_waitcnt vmcnt(7)
    buffer_load_dwordx4 v[124:127], v1, s[56:59], s73 offen offset:3072 nt
    s_add_u32 s73, s73, 16384
    v_mfma_f32_16x16x32_bf16 v[20:23], v[16:19], v[92:95], v[20:23]
    v_and_b32_dpp v12, v37, v8 row_newbcast:1 row_mask:0xf bank_mask:0xf
    v_and_b32_dpp v13, v37, v9 row_newbcast:1 row_mask:0xf bank_mask:0xf
    v_and_b32_dpp v14, v37, v10 row_newbcast:1 row_mask:0xf bank_mask:0xf
    v_and_b32_dpp v15, v37, v11 row_newbcast:1 row_mask:0xf bank_mask:0xf
    s_waitcnt vmcnt(7)
    buffer_load_dwordx4 v[64:67], v1, s[56:59], s73 offen offset:0 nt
    v_mfma_f32_16x16x32_bf16 v[20:23], v[12:15], v[96:99], v[20:23]
    v_and_b32_dpp v16, v37, v8 row_newbcast:9 row_mask:0xf bank_mask:0xf
    v_and_b32_dpp v17, v37, v9 row_newbcast:9 row_mask:0xf bank_mask:0xf
    v_and_b32_dpp v18, v37, v10 row_newbcast:9 row_mask:0xf bank_mask:0xf
    v_and_b32_dpp v19, v37, v11 row_newbcast:9 row_mask:0xf bank_mask:0xf
    s_waitcnt vmcnt(7)
    buffer_load_dwordx4 v[68:71], v1, s[56:59], s73 offen offset:1024 nt
    v_mfma_f32_16x16x32_bf16 v[20:23], v[16:19], v[100:103], v[20:23]
    v_and_b32_dpp v12, v37, v8 row_newbcast:5 row_mask:0xf bank_mask:0xf
    v_and_b32_dpp v13, v37, v9 row_newbcast:5 row_mask:0xf bank_mask:0xf
    v_and_b32_dpp v14, v37, v10 row_newbcast:5 row_mask:0xf bank_mask:0xf
    v_and_b32_dpp v15, v37, v11 row_newbcast:5 row_mask:0xf bank_mask:0xf
    s_waitcnt vmcnt(7)
    buffer_load_dwordx4 v[72:75], v1, s[56:59], s73 offen offset:2048 nt
    v_mfma_f32_16x16x32_bf16 v[20:23], v[12:15], v[104:107], v[20:23]
    v_and_b32_dpp v16, v37, v8 row_newbcast:13 row_mask:0xf bank_mask:0xf
    v_and_b32_dpp v17, v37, v9 row_newbcast:13 row_mask:0xf bank_mask:0xf
    v_and_b32_dpp v18, v37, v10 row_newbcast:13 row_mask:0xf bank_mask:0xf
    v_and_b32_dpp v19, v37, v11 row_newbcast:13 row_mask:0xf bank_mask:0xf
    s_waitcnt vmcnt(7)
    buffer_load_dwordx4 v[76:79], v1, s[56:59], s73 offen offset:3072 nt
    s_add_u32 s73, s73, 16384
    v_mfma_f32_16x16x32_bf16 v[20:23], v[16:19], v[108:111], v[20:23]
    v_and_b32_dpp v12, v37, v8 row_newbcast:3 row_mask:0xf bank_mask:0xf
    v_and_b32_dpp v13, v37, v9 row_newbcast:3 row_mask:0xf bank_mask:0xf
    v_and_b32_dpp v14, v37, v10 row_newbcast:3 row_mask:0xf bank_mask:0xf
    v_and_b32_dpp v15, v37, v11 row_newbcast:3 row_mask:0xf bank_mask:0xf
    s_waitcnt vmcnt(7)
    buffer_load_dwordx4 v[80:83], v1, s[56:59], s73 offen offset:0 nt
    v_mfma_f32_16x16x32_bf16 v[20:23], v[12:15], v[112:115], v[20:23]
    v_and_b32_dpp v16, v37, v8 row_newbcast:11 row_mask:0xf bank_mask:0xf
    v_and_b32_dpp v17, v37, v9 row_newbcast:11 row_mask:0xf bank_mask:0xf
    v_and_b32_dpp v18, v37, v10 row_newbcast:11 row_mask:0xf bank_mask:0xf
    v_and_b32_dpp v19, v37, v11 row_newbcast:11 row_mask:0xf bank_mask:0xf
    s_waitcnt vmcnt(7)
    buffer_load_dwordx4 v[84:87], v1, s[56:59], s73 offen offset:1024 nt
    v_mfma_f32_16x16x32_bf16 v[20:23], v[16:19], v[116:119], v[20:23]
    v_and_b32_dpp v12, v37, v8 row_newbcast:7 row_mask:0xf bank_mask:0xf
    v_and_b32_dpp v13, v37, v9 row_newbcast:7 row_mask:0xf bank_mask:0xf
    v_and_b32_dpp v14, v37, v10 row_newbcast:7 row_mask:0xf bank_mask:0xf
    v_and_b32_dpp v15, v37, v11 row_newbcast:7 row_mask:0xf bank_mask:0xf
    s_waitcnt vmcnt(7)
    buffer_load_dwordx4 v[88:91], v1, s[56:59], s73 offen offset:2048 nt
    v_mfma_f32_16x16x32_bf16 v[20:23], v[12:15], v[120:123], v[20:23]
    v_and_b32_dpp v16, v37, v8 row_newbcast:15 row_mask:0xf bank_mask:0xf
    v_and_b32_dpp v17, v37, v9 row_newbcast:15 row_mask:0xf bank_mask:0xf
    v_and_b32_dpp v18, v37, v10 row_newbcast:15 row_mask:0xf bank_mask:0xf
    v_and_b32_dpp v19, v37, v11 row_newbcast:15 row_mask:0xf bank_mask:0xf
    s_waitcnt vmcnt(7)
    buffer_load_dwordx4 v[92:95], v1, s[56:59], s73 offen offset:3072 nt
    s_add_u32 s73, s73, 16384
    v_mfma_f32_16x16x32_bf16 v[20:23], v[16:19], v[124:127], v[20:23]
    v_and_b32_dpp v12, v39, v8 row_newbcast:0 row_mask:0xf bank_mask:0xf
    v_and_b32_dpp v13, v39, v9 row_newbcast:0 row_mask:0xf bank_mask:0xf
    v_and_b32_dpp v14, v39, v10 row_newbcast:0 row_mask:0xf bank_mask:0xf
    v_and_b32_dpp v15, v39, v11 row_newbcast:0 row_mask:0xf bank_mask:0xf
    v_mov_b32 v37, v39
    s_waitcnt vmcnt(7)
    buffer_load_dwordx4 v[96:99], v1, s[56:59], s73 offen offset:0 nt
    v_mfma_f32_16x16x32_bf16 v[20:23], v[12:15], v[64:67], v[20:23]
    v_and_b32_dpp v16, v37, v8 row_newbcast:8 row_mask:0xf bank_mask:0xf
    v_and_b32_dpp v17, v37, v9 row_newbcast:8 row_mask:0xf bank_mask:0xf
    v_and_b32_dpp v18, v37, v10 row_newbcast:8 row_mask:0xf bank_mask:0xf
    v_and_b32_dpp v19, v37, v11 row_newbcast:8 row_mask:0xf bank_mask:0xf
    s_waitcnt vmcnt(7)
    buffer_load_dwordx4 v[100:103], v1, s[56:59], s73 offen offset:1024 nt
    v_mfma_f32_16x16x32_bf16 v[20:23], v[16:19], v[68:71], v[20:23]
    v_and_b32_dpp v12, v37, v8 row_newbcast:4 row_mask:0xf bank_mask:0xf
    v_and_b32_dpp v13, v37, v9 row_newbcast:4 row_mask:0xf bank_mask:0xf
    v_and_b32_dpp v14, v37, v10 row_newbcast:4 row_mask:0xf bank_mask:0xf
    v_and_b32_dpp v15, v37, v11 row_newbcast:4 row_mask:0xf bank_mask:0xf
    v_add_f32_dpp v36, v36, v36 row_ror:8 row_mask:0xf bank_mask:0xf
    s_nop 1
    v_add_f32_dpp v36, v36, v36 row_ror:4 row_mask:0xf bank_mask:0xf
    s_nop 1
    v_add_f32_dpp v36, v36, v36 row_ror:2 row_mask:0xf bank_mask:0xf
    s_nop 1
    v_add_f32_dpp v36, v36, v36 row_ror:1 row_mask:0xf bank_mask:0xf
    v_mov_b32 v33, v36
    s_nop 1
    v_permlane16_swap_b32 v36, v33
    v_add_f32 v36, v36, v33
    v_mov_b32 v33, v36
    s_nop 1
    v_permlane32_swap_b32 v36, v33
    v_add_f32 v36, v36, v33
    s_waitcnt vmcnt(7)
    buffer_load_dwordx4 v[104:107], v1, s[56:59], s73 offen offset:2048 nt
    v_mfma_f32_16x16x32_bf16 v[20:23], v[12:15], v[72:75], v[20:23]
    v_and_b32_dpp v16, v37, v8 row_newbcast:12 row_mask:0xf bank_mask:0xf
    v_and_b32_dpp v17, v37, v9 row_newbcast:12 row_mask:0xf bank_mask:0xf
    v_and_b32_dpp v18, v37, v10 row_newbcast:12 row_mask:0xf bank_mask:0xf
    v_and_b32_dpp v19, v37, v11 row_newbcast:12 row_mask:0xf bank_mask:0xf
    s_waitcnt vmcnt(7)
    buffer_load_dwordx4 v[108:111], v1, s[56:59], s73 offen offset:3072 nt
    s_add_u32 s73, s73, 16384
    v_mfma_f32_16x16x32_bf16 v[20:23], v[16:19], v[76:79], v[20:23]
    v_and_b32_dpp v12, v37, v8 row_newbcast:2 row_mask:0xf bank_mask:0xf
    v_and_b32_dpp v13, v37, v9 row_newbcast:2 row_mask:0xf bank_mask:0xf
    v_and_b32_dpp v14, v37, v10 row_newbcast:2 row_mask:0xf bank_mask:0xf
    v_and_b32_dpp v15, v37, v11 row_newbcast:2 row_mask:0xf bank_mask:0xf
    s_waitcnt vmcnt(7)
    buffer_load_dwordx4 v[112:115], v1, s[56:59], s73 offen offset:0 nt
    v_mfma_f32_16x16x32_bf16 v[20:23], v[12:15], v[80:83], v[20:23]
    v_and_b32_dpp v16, v37, v8 row_newbcast:10 row_mask:0xf bank_mask:0xf
    v_and_b32_dpp v17, v37, v9 row_newbcast:10 row_mask:0xf bank_mask:0xf
    v_and_b32_dpp v18, v37, v10 row_newbcast:10 row_mask:0xf bank_mask:0xf
    v_and_b32_dpp v19, v37, v11 row_newbcast:10 row_mask:0xf bank_mask:0xf
    s_waitcnt vmcnt(7)
    buffer_load_dwordx4 v[116:119], v1, s[56:59], s73 offen offset:1024 nt
    v_mfma_f32_16x16x32_bf16 v[20:23], v[16:19], v[84:87], v[20:23]
    v_and_b32_dpp v12, v37, v8 row_newbcast:6 row_mask:0xf bank_mask:0xf
    v_and_b32_dpp v13, v37, v9 row_newbcast:6 row_mask:0xf bank_mask:0xf
    v_and_b32_dpp v14, v37, v10 row_newbcast:6 row_mask:0xf bank_mask:0xf
    v_and_b32_dpp v15, v37, v11 row_newbcast:6 row_mask:0xf bank_mask:0xf
    s_waitcnt vmcnt(7)
    buffer_load_dwordx4 v[120:123], v1, s[56:59], s73 offen offset:2048 nt
    v_mfma_f32_16x16x32_bf16 v[20:23], v[12:15], v[88:91], v[20:23]
    v_and_b32_dpp v16, v37, v8 row_newbcast:14 row_mask:0xf bank_mask:0xf
    v_and_b32_dpp v17, v37, v9 row_newbcast:14 row_mask:0xf bank_mask:0xf
    v_and_b32_dpp v18, v37, v10 row_newbcast:14 row_mask:0xf bank_mask:0xf
    v_and_b32_dpp v19, v37, v11 row_newbcast:14 row_mask:0xf bank_mask:0xf
    s_waitcnt vmcnt(7)
    buffer_load_dwordx4 v[124:127], v1, s[56:59], s73 offen offset:3072 nt
    s_add_u32 s73, s73, 16384
    v_mfma_f32_16x16x32_bf16 v[20:23], v[16:19], v[92:95], v[20:23]
    v_and_b32_dpp v12, v37, v8 row_newbcast:1 row_mask:0xf bank_mask:0xf
    v_and_b32_dpp v13, v37, v9 row_newbcast:1 row_mask:0xf bank_mask:0xf
    v_and_b32_dpp v14, v37, v10 row_newbcast:1 row_mask:0xf bank_mask:0xf
    v_and_b32_dpp v15, v37, v11 row_newbcast:1 row_mask:0xf bank_mask:0xf
    s_waitcnt vmcnt(7)
    s_nop 0
    v_mfma_f32_16x16x32_bf16 v[20:23], v[12:15], v[96:99], v[20:23]
    v_and_b32_dpp v16, v37, v8 row_newbcast:9 row_mask:0xf bank_mask:0xf
    v_and_b32_dpp v17, v37, v9 row_newbcast:9 row_mask:0xf bank_mask:0xf
    v_and_b32_dpp v18, v37, v10 row_newbcast:9 row_mask:0xf bank_mask:0xf
    v_and_b32_dpp v19, v37, v11 row_newbcast:9 row_mask:0xf bank_mask:0xf
    s_waitcnt vmcnt(6)
    s_nop 0
    v_mfma_f32_16x16x32_bf16 v[20:23], v[16:19], v[100:103], v[20:23]
    v_and_b32_dpp v12, v37, v8 row_newbcast:5 row_mask:0xf bank_mask:0xf
    v_and_b32_dpp v13, v37, v9 row_newbcast:5 row_mask:0xf bank_mask:0xf
    v_and_b32_dpp v14, v37, v10 row_newbcast:5 row_mask:0xf bank_mask:0xf
    v_and_b32_dpp v15, v37, v11 row_newbcast:5 row_mask:0xf bank_mask:0xf
    s_waitcnt vmcnt(5)
    s_nop 0
    v_mfma_f32_16x16x32_bf16 v[20:23], v[12:15], v[104:107], v[20:23]
    v_and_b32_dpp v16, v37, v8 row_newbcast:13 row_mask:0xf bank_mask:0xf
    v_and_b32_dpp v17, v37, v9 row_newbcast:13 row_mask:0xf bank_mask:0xf
    v_and_b32_dpp v18, v37, v10 row_newbcast:13 row_mask:0xf bank_mask:0xf
    v_and_b32_dpp v19, v37, v11 row_newbcast:13 row_mask:0xf bank_mask:0xf
    s_waitcnt vmcnt(4)
    s_nop 0
    v_mfma_f32_16x16x32_bf16 v[20:23], v[16:19], v[108:111], v[20:23]
    v_and_b32_dpp v12, v37, v8 row_newbcast:3 row_mask:0xf bank_mask:0xf
    v_and_b32_dpp v13, v37, v9 row_newbcast:3 row_mask:0xf bank_mask:0xf
    v_and_b32_dpp v14, v37, v10 row_newbcast:3 row_mask:0xf bank_mask:0xf
    v_and_b32_dpp v15, v37, v11 row_newbcast:3 row_mask:0xf bank_mask:0xf
    s_waitcnt vmcnt(3)
    s_nop 0
    v_mfma_f32_16x16x32_bf16 v[20:23], v[12:15], v[112:115], v[20:23]
    v_and_b32_dpp v16, v37, v8 row_newbcast:11 row_mask:0xf bank_mask:0xf
    v_and_b32_dpp v17, v37, v9 row_newbcast:11 row_mask:0xf bank_mask:0xf
    v_and_b32_dpp v18, v37, v10 row_newbcast:11 row_mask:0xf bank_mask:0xf
    v_and_b32_dpp v19, v37, v11 row_newbcast:11 row_mask:0xf bank_mask:0xf
    s_waitcnt vmcnt(2)
    s_nop 0
    v_mfma_f32_16x16x32_bf16 v[20:23], v[16:19], v[116:119], v[20:23]
    v_and_b32_dpp v12, v37, v8 row_newbcast:7 row_mask:0xf bank_mask:0xf
    v_and_b32_dpp v13, v37, v9 row_newbcast:7 row_mask:0xf bank_mask:0xf
    v_and_b32_dpp v14, v37, v10 row_newbcast:7 row_mask:0xf bank_mask:0xf
    v_and_b32_dpp v15, v37, v11 row_newbcast:7 row_mask:0xf bank_mask:0xf
    s_waitcnt vmcnt(1)
    s_nop 0
    v_mfma_f32_16x16x32_bf16 v[20:23], v[12:15], v[120:123], v[20:23]
    v_and_b32_dpp v16, v37, v8 row_newbcast:15 row_mask:0xf bank_mask:0xf
    v_and_b32_dpp v17, v37, v9 row_newbcast:15 row_mask:0xf bank_mask:0xf
    v_and_b32_dpp v18, v37, v10 row_newbcast:15 row_mask:0xf bank_mask:0xf
    v_and_b32_dpp v19, v37, v11 row_newbcast:15 row_mask:0xf bank_mask:0xf
    s_waitcnt vmcnt(0)
    s_nop 0
    v_mfma_f32_16x16x32_bf16 v[20:23], v[16:19], v[124:127], v[20:23]
    v_and_b32 v33, 15, v0
    v_lshlrev_b32 v33, 5, v33
    v_lshrrev_b32 v34, 4, v0
    v_lshlrev_b32 v34, 4, v34
    s_lshl_b32 s46, s38, 9
    v_add3_u32 v33, v33, v34, s46
    s_lshl_b32 s46, s38, 2
    v_mov_b32 v34, s46
    s_mov_b64 exec, 1
    ds_write_b32 v34, v35 offset:4096
    ds_write_b32 v34, v36 offset:4112
    s_mov_b32 exec_lo, -1
    s_mov_b32 exec_hi, 0
    ds_write_b128 v33, v[20:23] offset:2048
    s_waitcnt lgkmcnt(0)
    s_barrier
    s_endpgm
L_aux:
    v_lshrrev_b32 v1, 4, v0
    v_and_b32 v2, 15, v0
    v_lshlrev_b32 v26, 13, v1
    v_lshl_add_u32 v26, v2, 4, v26
    s_lshl_b32 s46, s36, 10
    s_lshl_b32 s47, s38, 8
    s_add_u32 s46, s46, s47
    s_lshl_b32 s48, s36, 2
    v_add_u32 v22, s48, v2
    v_and_b32 v22, 31, v22
    v_lshlrev_b32 v22, 3, v22
    v_lshl_add_u32 v22, v1, 1, v22
    v_add_u32 v22, s46, v22
    s_lshl_b32 s48, s36, 2
    v_add_u32 v25, s48, v2
    v_add_u32 v25, 16, v25
    v_and_b32 v25, 31, v25
    v_lshlrev_b32 v25, 3, v25
    v_lshl_add_u32 v25, v1, 1, v25
    v_add_u32 v25, s46, v25
    s_lshl_b32 s72, s38, 20
    s_lshl_b32 s73, s36, 17
    v_lshrrev_b32 v24, 1, v2
    s_lshl_b32 s47, s36, 5
    s_lshl_b32 s48, s38, 3
    s_add_u32 s47, s47, s48
    v_add_u32 v24, s47, v24
    v_lshlrev_b32 v24, 7, v24
    s_lshl_b32 s47, s51, 7
    v_mov_b32 v29, s47
    s_lshl_b32 s47, s37, 8
    s_sub_u32 s48, 0x400000, s47
    s_waitcnt lgkmcnt(0)
    s_add_u32 s56, s14, s47
    s_addc_u32 s57, s15, 0
    s_mov_b32 s58, s48
    s_mov_b32 s59, 0x20000
    s_mov_b32 s52, s8
    s_mov_b32 s53, s9
    s_mov_b32 s54, 8256
    s_mov_b32 s55, 0x20000
    buffer_load_ushort v20, v22, s[52:55], 0 offen
    buffer_load_ushort v21, v25, s[52:55], 0 offen
    s_add_u32 s49, s72, s73
    buffer_load_dwordx4 v[128:131], v26, s[56:59], s49 offen
    s_add_u32 s73, s73, 32768
    s_and_b32 s73, s73, 0xfffff
    s_add_u32 s49, s72, s73
    buffer_load_dwordx4 v[132:135], v26, s[56:59], s49 offen
    s_add_u32 s73, s73, 32768
    s_and_b32 s73, s73, 0xfffff
    s_add_u32 s49, s72, s73
    buffer_load_dwordx4 v[136:139], v26, s[56:59], s49 offen
    s_add_u32 s73, s73, 32768
    s_and_b32 s73, s73, 0xfffff
    s_add_u32 s49, s72, s73
    buffer_load_dwordx4 v[140:143], v26, s[56:59], s49 offen
    s_add_u32 s73, s73, 32768
    s_and_b32 s73, s73, 0xfffff
    s_mov_b32 s60, s34
    s_mov_b32 s61, s35
    s_mov_b32 s62, 32768
    s_mov_b32 s63, 0x20000
    buffer_load_dwordx2 v[58:59], v24, s[60:63], 0 offen
    buffer_load_dwordx2 v[100:101], v29, s[60:63], 0 offen
    v_mov_b32 v3, 0
    v_mov_b32 v23, 0
    global_load_ushort v3, v23, s[28:29]
    global_load_ushort v3, v23, s[20:21]
    global_load_ushort v3, v23, s[22:23]
    global_load_ushort v3, v23, s[24:25]
    global_load_ushort v3, v23, s[26:27]
    global_load_ushort v3, v23, s[16:17]
    global_load_ushort v3, v23, s[30:31]
    v_mov_b32 v23, 1048576
    global_load_dword v3, v23, s[34:35]
    s_lshl_b32 s46, s51, 20
    s_lshr_b32 s47, s51, 12
    s_add_u32 s68, s12, s46
    s_addc_u32 s69, s13, s47
    s_mov_b32 s70, 1048576
    s_mov_b32 s71, 0x20000
    v_mov_b32 v23, 0
    buffer_load_dword v3, v23, s[68:71], 0 offen nt
    s_add_u32 s49, s72, s73
    buffer_load_dwordx4 v[144:147], v26, s[56:59], s49 offen
    s_add_u32 s73, s73, 32768
    s_and_b32 s73, s73, 0xfffff
    s_add_u32 s49, s72, s73
    buffer_load_dwordx4 v[148:151], v26, s[56:59], s49 offen
    s_add_u32 s73, s73, 32768
    s_and_b32 s73, s73, 0xfffff
    v_and_b32 v23, 15, v0
    v_and_b32 v24, 1, v23
    v_lshlrev_b32 v24, 4, v24
    v_mov_b32 v4, 0xffff
    v_lshlrev_b32 v24, v24, v4
    v_lshrrev_b32 v23, 1, v23
    v_cmp_eq_u32 vcc, 0, v23
    s_nop 1
    v_cndmask_b32 v4, 0, v24, vcc
    v_cmp_eq_u32 vcc, 1, v23
    s_nop 1
    v_cndmask_b32 v5, 0, v24, vcc
    v_cmp_eq_u32 vcc, 2, v23
    s_nop 1
    v_cndmask_b32 v6, 0, v24, vcc
    v_cmp_eq_u32 vcc, 3, v23
    s_nop 1
    v_cndmask_b32 v7, 0, v24, vcc
    v_mov_b32 v16, 0
    v_mov_b32 v17, 0
    v_mov_b32 v18, 0
    v_mov_b32 v19, 0
    s_waitcnt vmcnt(17)
    v_lshl_or_b32 v20, v20, 16, v20
    v_lshl_or_b32 v21, v21, 16, v21
    s_nop 0
    v_and_b32_dpp v8, v20, v4 row_newbcast:0 row_mask:0xf bank_mask:0xf
    v_and_b32_dpp v9, v20, v5 row_newbcast:0 row_mask:0xf bank_mask:0xf
    v_and_b32_dpp v10, v20, v6 row_newbcast:0 row_mask:0xf bank_mask:0xf
    v_and_b32_dpp v11, v20, v7 row_newbcast:0 row_mask:0xf bank_mask:0xf
    v_and_b32_dpp v12, v20, v4 row_newbcast:1 row_mask:0xf bank_mask:0xf
    v_and_b32_dpp v13, v20, v5 row_newbcast:1 row_mask:0xf bank_mask:0xf
    v_and_b32_dpp v14, v20, v6 row_newbcast:1 row_mask:0xf bank_mask:0xf
    v_and_b32_dpp v15, v20, v7 row_newbcast:1 row_mask:0xf bank_mask:0xf
    s_waitcnt vmcnt(16)
    s_add_u32 s49, s72, s73
    buffer_load_dwordx4 v[152:155], v26, s[56:59], s49 offen
    s_add_u32 s73, s73, 32768
    s_and_b32 s73, s73, 0xfffff
    v_mfma_f32_16x16x32_bf16 v[16:19], v[8:11], v[128:131], v[16:19]
    v_and_b32_dpp v8, v20, v4 row_newbcast:2 row_mask:0xf bank_mask:0xf
    v_and_b32_dpp v9, v20, v5 row_newbcast:2 row_mask:0xf bank_mask:0xf
    v_and_b32_dpp v10, v20, v6 row_newbcast:2 row_mask:0xf bank_mask:0xf
    v_and_b32_dpp v11, v20, v7 row_newbcast:2 row_mask:0xf bank_mask:0xf
    s_waitcnt vmcnt(16)
    s_add_u32 s49, s72, s73
    buffer_load_dwordx4 v[156:159], v26, s[56:59], s49 offen
    s_add_u32 s73, s73, 32768
    s_and_b32 s73, s73, 0xfffff
    v_mfma_f32_16x16x32_bf16 v[16:19], v[12:15], v[132:135], v[16:19]
    v_and_b32_dpp v12, v20, v4 row_newbcast:3 row_mask:0xf bank_mask:0xf
    v_and_b32_dpp v13, v20, v5 row_newbcast:3 row_mask:0xf bank_mask:0xf
    v_and_b32_dpp v14, v20, v6 row_newbcast:3 row_mask:0xf bank_mask:0xf
    v_and_b32_dpp v15, v20, v7 row_newbcast:3 row_mask:0xf bank_mask:0xf
    s_waitcnt vmcnt(16)
    s_add_u32 s49, s72, s73
    buffer_load_dwordx4 v[160:163], v26, s[56:59], s49 offen
    s_add_u32 s73, s73, 32768
    s_and_b32 s73, s73, 0xfffff
    v_mfma_f32_16x16x32_bf16 v[16:19], v[8:11], v[136:139], v[16:19]
    v_and_b32_dpp v8, v20, v4 row_newbcast:4 row_mask:0xf bank_mask:0xf
    v_and_b32_dpp v9, v20, v5 row_newbcast:4 row_mask:0xf bank_mask:0xf
    v_and_b32_dpp v10, v20, v6 row_newbcast:4 row_mask:0xf bank_mask:0xf
    v_and_b32_dpp v11, v20, v7 row_newbcast:4 row_mask:0xf bank_mask:0xf
    s_waitcnt vmcnt(16)
    s_add_u32 s49, s72, s73
    buffer_load_dwordx4 v[164:167], v26, s[56:59], s49 offen
    s_add_u32 s73, s73, 32768
    s_and_b32 s73, s73, 0xfffff
    v_mfma_f32_16x16x32_bf16 v[16:19], v[12:15], v[140:143], v[16:19]
    v_and_b32_dpp v12, v20, v4 row_newbcast:5 row_mask:0xf bank_mask:0xf
    v_and_b32_dpp v13, v20, v5 row_newbcast:5 row_mask:0xf bank_mask:0xf
    v_and_b32_dpp v14, v20, v6 row_newbcast:5 row_mask:0xf bank_mask:0xf
    v_and_b32_dpp v15, v20, v7 row_newbcast:5 row_mask:0xf bank_mask:0xf
    s_waitcnt vmcnt(5)
    s_add_u32 s49, s72, s73
    buffer_load_dwordx4 v[168:171], v26, s[56:59], s49 offen
    s_add_u32 s73, s73, 32768
    s_and_b32 s73, s73, 0xfffff
    v_mfma_f32_16x16x32_bf16 v[16:19], v[8:11], v[144:147], v[16:19]
    v_and_b32_dpp v8, v20, v4 row_newbcast:6 row_mask:0xf bank_mask:0xf
    v_and_b32_dpp v9, v20, v5 row_newbcast:6 row_mask:0xf bank_mask:0xf
    v_and_b32_dpp v10, v20, v6 row_newbcast:6 row_mask:0xf bank_mask:0xf
    v_and_b32_dpp v11, v20, v7 row_newbcast:6 row_mask:0xf bank_mask:0xf
    s_waitcnt vmcnt(5)
    s_add_u32 s49, s72, s73
    buffer_load_dwordx4 v[172:175], v26, s[56:59], s49 offen
    s_add_u32 s73, s73, 32768
    s_and_b32 s73, s73, 0xfffff
    v_mfma_f32_16x16x32_bf16 v[16:19], v[12:15], v[148:151], v[16:19]
    v_and_b32_dpp v12, v20, v4 row_newbcast:7 row_mask:0xf bank_mask:0xf
    v_and_b32_dpp v13, v20, v5 row_newbcast:7 row_mask:0xf bank_mask:0xf
    v_and_b32_dpp v14, v20, v6 row_newbcast:7 row_mask:0xf bank_mask:0xf
    v_and_b32_dpp v15, v20, v7 row_newbcast:7 row_mask:0xf bank_mask:0xf
    s_waitcnt vmcnt(5)
    s_add_u32 s49, s72, s73
    buffer_load_dwordx4 v[176:179], v26, s[56:59], s49 offen
    s_add_u32 s73, s73, 32768
    s_and_b32 s73, s73, 0xfffff
    v_mfma_f32_16x16x32_bf16 v[16:19], v[8:11], v[152:155], v[16:19]
    v_and_b32_dpp v8, v20, v4 row_newbcast:8 row_mask:0xf bank_mask:0xf
    v_and_b32_dpp v9, v20, v5 row_newbcast:8 row_mask:0xf bank_mask:0xf
    v_and_b32_dpp v10, v20, v6 row_newbcast:8 row_mask:0xf bank_mask:0xf
    v_and_b32_dpp v11, v20, v7 row_newbcast:8 row_mask:0xf bank_mask:0xf
    s_waitcnt vmcnt(5)
    s_add_u32 s49, s72, s73
    buffer_load_dwordx4 v[180:183], v26, s[56:59], s49 offen
    s_add_u32 s73, s73, 32768
    s_and_b32 s73, s73, 0xfffff
    v_mfma_f32_16x16x32_bf16 v[16:19], v[12:15], v[156:159], v[16:19]
    v_and_b32_dpp v12, v20, v4 row_newbcast:9 row_mask:0xf bank_mask:0xf
    v_and_b32_dpp v13, v20, v5 row_newbcast:9 row_mask:0xf bank_mask:0xf
    v_and_b32_dpp v14, v20, v6 row_newbcast:9 row_mask:0xf bank_mask:0xf
    v_and_b32_dpp v15, v20, v7 row_newbcast:9 row_mask:0xf bank_mask:0xf
    s_waitcnt vmcnt(5)
    s_add_u32 s49, s72, s73
    buffer_load_dwordx4 v[184:187], v26, s[56:59], s49 offen
    s_add_u32 s73, s73, 32768
    s_and_b32 s73, s73, 0xfffff
    v_mfma_f32_16x16x32_bf16 v[16:19], v[8:11], v[160:163], v[16:19]
    v_and_b32_dpp v8, v20, v4 row_newbcast:10 row_mask:0xf bank_mask:0xf
    v_and_b32_dpp v9, v20, v5 row_newbcast:10 row_mask:0xf bank_mask:0xf
    v_and_b32_dpp v10, v20, v6 row_newbcast:10 row_mask:0xf bank_mask:0xf
    v_and_b32_dpp v11, v20, v7 row_newbcast:10 row_mask:0xf bank_mask:0xf
    s_waitcnt vmcnt(5)
    s_add_u32 s49, s72, s73
    buffer_load_dwordx4 v[188:191], v26, s[56:59], s49 offen
    s_add_u32 s73, s73, 32768
    s_and_b32 s73, s73, 0xfffff
    v_mfma_f32_16x16x32_bf16 v[16:19], v[12:15], v[164:167], v[16:19]
    v_and_b32_dpp v12, v20, v4 row_newbcast:11 row_mask:0xf bank_mask:0xf
    v_and_b32_dpp v13, v20, v5 row_newbcast:11 row_mask:0xf bank_mask:0xf
    v_and_b32_dpp v14, v20, v6 row_newbcast:11 row_mask:0xf bank_mask:0xf
    v_and_b32_dpp v15, v20, v7 row_newbcast:11 row_mask:0xf bank_mask:0xf
    s_waitcnt vmcnt(5)
    s_add_u32 s49, s72, s73
    buffer_load_dwordx4 v[192:195], v26, s[56:59], s49 offen
    s_add_u32 s73, s73, 32768
    s_and_b32 s73, s73, 0xfffff
    v_mfma_f32_16x16x32_bf16 v[16:19], v[8:11], v[168:171], v[16:19]
    v_and_b32_dpp v8, v20, v4 row_newbcast:12 row_mask:0xf bank_mask:0xf
    v_and_b32_dpp v9, v20, v5 row_newbcast:12 row_mask:0xf bank_mask:0xf
    v_and_b32_dpp v10, v20, v6 row_newbcast:12 row_mask:0xf bank_mask:0xf
    v_and_b32_dpp v11, v20, v7 row_newbcast:12 row_mask:0xf bank_mask:0xf
    s_waitcnt vmcnt(5)
    s_add_u32 s49, s72, s73
    buffer_load_dwordx4 v[196:199], v26, s[56:59], s49 offen
    s_add_u32 s73, s73, 32768
    s_and_b32 s73, s73, 0xfffff
    v_mfma_f32_16x16x32_bf16 v[16:19], v[12:15], v[172:175], v[16:19]
    v_and_b32_dpp v12, v20, v4 row_newbcast:13 row_mask:0xf bank_mask:0xf
    v_and_b32_dpp v13, v20, v5 row_newbcast:13 row_mask:0xf bank_mask:0xf
    v_and_b32_dpp v14, v20, v6 row_newbcast:13 row_mask:0xf bank_mask:0xf
    v_and_b32_dpp v15, v20, v7 row_newbcast:13 row_mask:0xf bank_mask:0xf
    s_waitcnt vmcnt(5)
    s_add_u32 s49, s72, s73
    buffer_load_dwordx4 v[200:203], v26, s[56:59], s49 offen
    s_add_u32 s73, s73, 32768
    s_and_b32 s73, s73, 0xfffff
    v_mfma_f32_16x16x32_bf16 v[16:19], v[8:11], v[176:179], v[16:19]
    v_and_b32_dpp v8, v20, v4 row_newbcast:14 row_mask:0xf bank_mask:0xf
    v_and_b32_dpp v9, v20, v5 row_newbcast:14 row_mask:0xf bank_mask:0xf
    v_and_b32_dpp v10, v20, v6 row_newbcast:14 row_mask:0xf bank_mask:0xf
    v_and_b32_dpp v11, v20, v7 row_newbcast:14 row_mask:0xf bank_mask:0xf
    s_waitcnt vmcnt(5)
    s_add_u32 s49, s72, s73
    buffer_load_dwordx4 v[204:207], v26, s[56:59], s49 offen
    s_add_u32 s73, s73, 32768
    s_and_b32 s73, s73, 0xfffff
    v_mfma_f32_16x16x32_bf16 v[16:19], v[12:15], v[180:183], v[16:19]
    v_and_b32_dpp v12, v20, v4 row_newbcast:15 row_mask:0xf bank_mask:0xf
    v_and_b32_dpp v13, v20, v5 row_newbcast:15 row_mask:0xf bank_mask:0xf
    v_and_b32_dpp v14, v20, v6 row_newbcast:15 row_mask:0xf bank_mask:0xf
    v_and_b32_dpp v15, v20, v7 row_newbcast:15 row_mask:0xf bank_mask:0xf
    s_waitcnt vmcnt(5)
    s_add_u32 s49, s72, s73
    buffer_load_dwordx4 v[208:211], v26, s[56:59], s49 offen
    s_add_u32 s73, s73, 32768
    s_and_b32 s73, s73, 0xfffff
    v_mfma_f32_16x16x32_bf16 v[16:19], v[8:11], v[184:187], v[16:19]
    v_and_b32_dpp v8, v21, v4 row_newbcast:0 row_mask:0xf bank_mask:0xf
    v_and_b32_dpp v9, v21, v5 row_newbcast:0 row_mask:0xf bank_mask:0xf
    v_and_b32_dpp v10, v21, v6 row_newbcast:0 row_mask:0xf bank_mask:0xf
    v_and_b32_dpp v11, v21, v7 row_newbcast:0 row_mask:0xf bank_mask:0xf
    s_waitcnt vmcnt(5)
    s_add_u32 s49, s72, s73
    buffer_load_dwordx4 v[212:215], v26, s[56:59], s49 offen
    s_add_u32 s73, s73, 32768
    s_and_b32 s73, s73, 0xfffff
    v_mfma_f32_16x16x32_bf16 v[16:19], v[12:15], v[188:191], v[16:19]
    v_and_b32_dpp v12, v21, v4 row_newbcast:1 row_mask:0xf bank_mask:0xf
    v_and_b32_dpp v13, v21, v5 row_newbcast:1 row_mask:0xf bank_mask:0xf
    v_and_b32_dpp v14, v21, v6 row_newbcast:1 row_mask:0xf bank_mask:0xf
    v_and_b32_dpp v15, v21, v7 row_newbcast:1 row_mask:0xf bank_mask:0xf
    s_waitcnt vmcnt(5)
    s_add_u32 s49, s72, s73
    buffer_load_dwordx4 v[216:219], v26, s[56:59], s49 offen
    s_add_u32 s73, s73, 32768
    s_and_b32 s73, s73, 0xfffff
    v_mfma_f32_16x16x32_bf16 v[16:19], v[8:11], v[192:195], v[16:19]
    v_and_b32_dpp v8, v21, v4 row_newbcast:2 row_mask:0xf bank_mask:0xf
    v_and_b32_dpp v9, v21, v5 row_newbcast:2 row_mask:0xf bank_mask:0xf
    v_and_b32_dpp v10, v21, v6 row_newbcast:2 row_mask:0xf bank_mask:0xf
    v_and_b32_dpp v11, v21, v7 row_newbcast:2 row_mask:0xf bank_mask:0xf
    s_waitcnt vmcnt(5)
    s_add_u32 s49, s72, s73
    buffer_load_dwordx4 v[220:223], v26, s[56:59], s49 offen
    s_add_u32 s73, s73, 32768
    s_and_b32 s73, s73, 0xfffff
    v_mfma_f32_16x16x32_bf16 v[16:19], v[12:15], v[196:199], v[16:19]
    v_and_b32_dpp v12, v21, v4 row_newbcast:3 row_mask:0xf bank_mask:0xf
    v_and_b32_dpp v13, v21, v5 row_newbcast:3 row_mask:0xf bank_mask:0xf
    v_and_b32_dpp v14, v21, v6 row_newbcast:3 row_mask:0xf bank_mask:0xf
    v_and_b32_dpp v15, v21, v7 row_newbcast:3 row_mask:0xf bank_mask:0xf
    s_waitcnt vmcnt(5)
    s_add_u32 s49, s72, s73
    buffer_load_dwordx4 v[224:227], v26, s[56:59], s49 offen
    s_add_u32 s73, s73, 32768
    s_and_b32 s73, s73, 0xfffff
    v_mfma_f32_16x16x32_bf16 v[16:19], v[8:11], v[200:203], v[16:19]
    v_and_b32_dpp v8, v21, v4 row_newbcast:4 row_mask:0xf bank_mask:0xf
    v_and_b32_dpp v9, v21, v5 row_newbcast:4 row_mask:0xf bank_mask:0xf
    v_and_b32_dpp v10, v21, v6 row_newbcast:4 row_mask:0xf bank_mask:0xf
    v_and_b32_dpp v11, v21, v7 row_newbcast:4 row_mask:0xf bank_mask:0xf
    s_waitcnt vmcnt(5)
    s_add_u32 s49, s72, s73
    buffer_load_dwordx4 v[228:231], v26, s[56:59], s49 offen
    s_add_u32 s73, s73, 32768
    s_and_b32 s73, s73, 0xfffff
    v_mfma_f32_16x16x32_bf16 v[16:19], v[12:15], v[204:207], v[16:19]
    v_and_b32_dpp v12, v21, v4 row_newbcast:5 row_mask:0xf bank_mask:0xf
    v_and_b32_dpp v13, v21, v5 row_newbcast:5 row_mask:0xf bank_mask:0xf
    v_and_b32_dpp v14, v21, v6 row_newbcast:5 row_mask:0xf bank_mask:0xf
    v_and_b32_dpp v15, v21, v7 row_newbcast:5 row_mask:0xf bank_mask:0xf
    s_waitcnt vmcnt(5)
    s_add_u32 s49, s72, s73
    buffer_load_dwordx4 v[232:235], v26, s[56:59], s49 offen
    s_add_u32 s73, s73, 32768
    s_and_b32 s73, s73, 0xfffff
    v_mfma_f32_16x16x32_bf16 v[16:19], v[8:11], v[208:211], v[16:19]
    v_and_b32_dpp v8, v21, v4 row_newbcast:6 row_mask:0xf bank_mask:0xf
    v_and_b32_dpp v9, v21, v5 row_newbcast:6 row_mask:0xf bank_mask:0xf
    v_and_b32_dpp v10, v21, v6 row_newbcast:6 row_mask:0xf bank_mask:0xf
    v_and_b32_dpp v11, v21, v7 row_newbcast:6 row_mask:0xf bank_mask:0xf
    s_waitcnt vmcnt(5)
    s_add_u32 s49, s72, s73
    buffer_load_dwordx4 v[236:239], v26, s[56:59], s49 offen
    s_add_u32 s73, s73, 32768
    s_and_b32 s73, s73, 0xfffff
    v_mfma_f32_16x16x32_bf16 v[16:19], v[12:15], v[212:215], v[16:19]
    v_and_b32_dpp v12, v21, v4 row_newbcast:7 row_mask:0xf bank_mask:0xf
    v_and_b32_dpp v13, v21, v5 row_newbcast:7 row_mask:0xf bank_mask:0xf
    v_and_b32_dpp v14, v21, v6 row_newbcast:7 row_mask:0xf bank_mask:0xf
    v_and_b32_dpp v15, v21, v7 row_newbcast:7 row_mask:0xf bank_mask:0xf
    s_waitcnt vmcnt(5)
    s_add_u32 s49, s72, s73
    buffer_load_dwordx4 v[240:243], v26, s[56:59], s49 offen
    s_add_u32 s73, s73, 32768
    s_and_b32 s73, s73, 0xfffff
    v_mfma_f32_16x16x32_bf16 v[16:19], v[8:11], v[216:219], v[16:19]
    v_and_b32_dpp v8, v21, v4 row_newbcast:8 row_mask:0xf bank_mask:0xf
    v_and_b32_dpp v9, v21, v5 row_newbcast:8 row_mask:0xf bank_mask:0xf
    v_and_b32_dpp v10, v21, v6 row_newbcast:8 row_mask:0xf bank_mask:0xf
    v_and_b32_dpp v11, v21, v7 row_newbcast:8 row_mask:0xf bank_mask:0xf
    s_waitcnt vmcnt(5)
    s_add_u32 s49, s72, s73
    buffer_load_dwordx4 v[244:247], v26, s[56:59], s49 offen
    s_add_u32 s73, s73, 32768
    s_and_b32 s73, s73, 0xfffff
    v_mfma_f32_16x16x32_bf16 v[16:19], v[12:15], v[220:223], v[16:19]
    v_and_b32_dpp v12, v21, v4 row_newbcast:9 row_mask:0xf bank_mask:0xf
    v_and_b32_dpp v13, v21, v5 row_newbcast:9 row_mask:0xf bank_mask:0xf
    v_and_b32_dpp v14, v21, v6 row_newbcast:9 row_mask:0xf bank_mask:0xf
    v_and_b32_dpp v15, v21, v7 row_newbcast:9 row_mask:0xf bank_mask:0xf
    s_waitcnt vmcnt(5)
    s_add_u32 s49, s72, s73
    buffer_load_dwordx4 v[248:251], v26, s[56:59], s49 offen
    s_add_u32 s73, s73, 32768
    s_and_b32 s73, s73, 0xfffff
    v_mfma_f32_16x16x32_bf16 v[16:19], v[8:11], v[224:227], v[16:19]
    v_and_b32_dpp v8, v21, v4 row_newbcast:10 row_mask:0xf bank_mask:0xf
    v_and_b32_dpp v9, v21, v5 row_newbcast:10 row_mask:0xf bank_mask:0xf
    v_and_b32_dpp v10, v21, v6 row_newbcast:10 row_mask:0xf bank_mask:0xf
    v_and_b32_dpp v11, v21, v7 row_newbcast:10 row_mask:0xf bank_mask:0xf
    s_waitcnt vmcnt(5)
    s_add_u32 s49, s72, s73
    buffer_load_dwordx4 v[252:255], v26, s[56:59], s49 offen
    v_mfma_f32_16x16x32_bf16 v[16:19], v[12:15], v[228:231], v[16:19]
    v_and_b32_dpp v12, v21, v4 row_newbcast:11 row_mask:0xf bank_mask:0xf
    v_and_b32_dpp v13, v21, v5 row_newbcast:11 row_mask:0xf bank_mask:0xf
    v_and_b32_dpp v14, v21, v6 row_newbcast:11 row_mask:0xf bank_mask:0xf
    v_and_b32_dpp v15, v21, v7 row_newbcast:11 row_mask:0xf bank_mask:0xf
    s_waitcnt vmcnt(5)
    v_mfma_f32_16x16x32_bf16 v[16:19], v[8:11], v[232:235], v[16:19]
    v_and_b32_dpp v8, v21, v4 row_newbcast:12 row_mask:0xf bank_mask:0xf
    v_and_b32_dpp v9, v21, v5 row_newbcast:12 row_mask:0xf bank_mask:0xf
    v_and_b32_dpp v10, v21, v6 row_newbcast:12 row_mask:0xf bank_mask:0xf
    v_and_b32_dpp v11, v21, v7 row_newbcast:12 row_mask:0xf bank_mask:0xf
    s_waitcnt vmcnt(4)
    v_mfma_f32_16x16x32_bf16 v[16:19], v[12:15], v[236:239], v[16:19]
    v_and_b32_dpp v12, v21, v4 row_newbcast:13 row_mask:0xf bank_mask:0xf
    v_and_b32_dpp v13, v21, v5 row_newbcast:13 row_mask:0xf bank_mask:0xf
    v_and_b32_dpp v14, v21, v6 row_newbcast:13 row_mask:0xf bank_mask:0xf
    v_and_b32_dpp v15, v21, v7 row_newbcast:13 row_mask:0xf bank_mask:0xf
    s_waitcnt vmcnt(3)
    v_mfma_f32_16x16x32_bf16 v[16:19], v[8:11], v[240:243], v[16:19]
    v_and_b32_dpp v8, v21, v4 row_newbcast:14 row_mask:0xf bank_mask:0xf
    v_and_b32_dpp v9, v21, v5 row_newbcast:14 row_mask:0xf bank_mask:0xf
    v_and_b32_dpp v10, v21, v6 row_newbcast:14 row_mask:0xf bank_mask:0xf
    v_and_b32_dpp v11, v21, v7 row_newbcast:14 row_mask:0xf bank_mask:0xf
    s_waitcnt vmcnt(2)
    v_mfma_f32_16x16x32_bf16 v[16:19], v[12:15], v[244:247], v[16:19]
    v_and_b32_dpp v12, v21, v4 row_newbcast:15 row_mask:0xf bank_mask:0xf
    v_and_b32_dpp v13, v21, v5 row_newbcast:15 row_mask:0xf bank_mask:0xf
    v_and_b32_dpp v14, v21, v6 row_newbcast:15 row_mask:0xf bank_mask:0xf
    v_and_b32_dpp v15, v21, v7 row_newbcast:15 row_mask:0xf bank_mask:0xf
    s_waitcnt vmcnt(1)
    v_mfma_f32_16x16x32_bf16 v[16:19], v[8:11], v[248:251], v[16:19]
    s_waitcnt vmcnt(0)
    v_mfma_f32_16x16x32_bf16 v[16:19], v[12:15], v[252:255], v[16:19]
    v_lshlrev_b32 v22, 5, v2
    v_lshl_add_u32 v22, v1, 4, v22
    s_lshl_b32 s46, s38, 9
    v_add_u32 v22, s46, v22
    s_mov_b32 exec_lo, -1
    s_mov_b32 exec_hi, 0
    s_nop 1
    ds_write_b128 v22, v[16:19] offset:0
    s_mov_b64 exec, -1
    s_waitcnt lgkmcnt(0)
    s_barrier
    v_add_u32 v58, 1, v58
    v_add_u32 v59, 1, v59
    v_add_u32 v100, 1, v100
    v_add_u32 v101, 1, v101
    v_readfirstlane_b32 s74, v100
    v_readfirstlane_b32 s75, v101
    s_lshl_b32 s46, s36, 10
    s_add_u32 s52, s8, s46
    s_addc_u32 s53, s9, 0
    s_mov_b32 s54, 1088
    s_mov_b32 s55, 0x20000
    v_lshlrev_b32 v22, 4, v0
    buffer_load_dwordx4 v[60:63], v22, s[52:55], 0 offen
    s_lshl_b32 s47, s37, 5
    v_lshlrev_b32 v23, 1, v2
    buffer_load_ushort v27, v23, s[52:55], s47 offen
    s_mov_b32 s52, s28
    s_mov_b32 s53, s29
    s_mov_b32 s54, 1024
    s_mov_b32 s55, 0x20000
    buffer_load_dwordx4 v[68:71], v22, s[52:55], 0 offen
    s_mul_i32 s47, s38, 896
    v_lshlrev_b32 v23, 1, v0
    s_mov_b32 s52, s20
    s_mov_b32 s53, s21
    s_mov_b32 s54, 3648
    s_mov_b32 s55, 0x20000
    buffer_load_ushort v36, v23, s[52:55], s47 offen offset:0
    buffer_load_ushort v37, v23, s[52:55], s47 offen offset:128
    buffer_load_ushort v38, v23, s[52:55], s47 offen offset:256
    buffer_load_ushort v39, v23, s[52:55], s47 offen offset:384
    buffer_load_ushort v40, v23, s[52:55], s47 offen offset:512
    buffer_load_ushort v41, v23, s[52:55], s47 offen offset:640
    buffer_load_ushort v42, v23, s[52:55], s47 offen offset:768
    s_mov_b32 s52, s22
    s_mov_b32 s53, s23
    s_mov_b32 s54, 3648
    s_mov_b32 s55, 0x20000
    buffer_load_ushort v43, v23, s[52:55], s47 offen offset:0
    buffer_load_ushort v44, v23, s[52:55], s47 offen offset:128
    buffer_load_ushort v45, v23, s[52:55], s47 offen offset:256
    buffer_load_ushort v46, v23, s[52:55], s47 offen offset:384
    buffer_load_ushort v47, v23, s[52:55], s47 offen offset:512
    buffer_load_ushort v48, v23, s[52:55], s47 offen offset:640
    buffer_load_ushort v49, v23, s[52:55], s47 offen offset:768
    s_mov_b32 s52, s24
    s_mov_b32 s53, s25
    s_mov_b32 s54, 3648
    s_mov_b32 s55, 0x20000
    buffer_load_ushort v50, v23, s[52:55], s47 offen offset:0
    buffer_load_ushort v51, v23, s[52:55], s47 offen offset:128
    buffer_load_ushort v52, v23, s[52:55], s47 offen offset:256
    buffer_load_ushort v53, v23, s[52:55], s47 offen offset:384
    buffer_load_ushort v54, v23, s[52:55], s47 offen offset:512
    buffer_load_ushort v55, v23, s[52:55], s47 offen offset:640
    buffer_load_ushort v56, v23, s[52:55], s47 offen offset:768
    s_mov_b32 s52, s26
    s_mov_b32 s53, s27
    s_mov_b32 s54, 64
    s_mov_b32 s55, 0x20000
    v_mov_b32 v24, 0
    buffer_load_ushort v30, v24, s[52:55], 0 offen
    s_waitcnt vmcnt(0)
    s_lshl_b32 s46, s37, 17
    s_add_u32 s56, s16, s46
    s_addc_u32 s57, s17, 0
    s_mov_b32 s58, 131072
    s_mov_b32 s59, 0x20000
    v_lshlrev_b32 v26, 10, v1
    v_lshl_add_u32 v26, v2, 4, v26
    s_lshl_b32 s46, s38, 8
    v_add_u32 v26, s46, v26
    s_lshl_b32 s72, s36, 14
    buffer_load_dwordx4 v[128:131], v26, s[56:59], s72 offen
    s_add_u32 s72, s72, 4096
    s_and_b32 s72, s72, 0x1ffff
    s_waitcnt vmcnt(0)
    buffer_load_dwordx4 v[132:135], v26, s[56:59], s72 offen
    s_add_u32 s72, s72, 4096
    s_and_b32 s72, s72, 0x1ffff
    s_waitcnt vmcnt(0)
    buffer_load_dwordx4 v[136:139], v26, s[56:59], s72 offen
    s_add_u32 s72, s72, 4096
    s_and_b32 s72, s72, 0x1ffff
    s_waitcnt vmcnt(0)
    buffer_load_dwordx4 v[140:143], v26, s[56:59], s72 offen
    s_add_u32 s72, s72, 4096
    s_and_b32 s72, s72, 0x1ffff
    s_waitcnt vmcnt(0)
    buffer_load_dwordx4 v[144:147], v26, s[56:59], s72 offen
    s_add_u32 s72, s72, 4096
    s_and_b32 s72, s72, 0x1ffff
    s_waitcnt vmcnt(0)
    buffer_load_dwordx4 v[148:151], v26, s[56:59], s72 offen
    s_add_u32 s72, s72, 4096
    s_and_b32 s72, s72, 0x1ffff
    s_waitcnt vmcnt(0)
    buffer_load_dwordx4 v[152:155], v26, s[56:59], s72 offen
    s_add_u32 s72, s72, 4096
    s_and_b32 s72, s72, 0x1ffff
    s_waitcnt vmcnt(0)
    buffer_load_dwordx4 v[156:159], v26, s[56:59], s72 offen
    s_add_u32 s72, s72, 4096
    s_and_b32 s72, s72, 0x1ffff
    s_waitcnt vmcnt(0)
    buffer_load_dwordx4 v[160:163], v26, s[56:59], s72 offen
    s_add_u32 s72, s72, 4096
    s_and_b32 s72, s72, 0x1ffff
    s_waitcnt vmcnt(0)
    buffer_load_dwordx4 v[164:167], v26, s[56:59], s72 offen
    s_add_u32 s72, s72, 4096
    s_and_b32 s72, s72, 0x1ffff
    s_waitcnt vmcnt(0)
    buffer_load_dwordx4 v[168:171], v26, s[56:59], s72 offen
    s_add_u32 s72, s72, 4096
    s_and_b32 s72, s72, 0x1ffff
    s_waitcnt vmcnt(0)
    buffer_load_dwordx4 v[172:175], v26, s[56:59], s72 offen
    s_add_u32 s72, s72, 4096
    s_and_b32 s72, s72, 0x1ffff
    s_waitcnt vmcnt(0)
    buffer_load_dwordx4 v[176:179], v26, s[56:59], s72 offen
    s_add_u32 s72, s72, 4096
    s_and_b32 s72, s72, 0x1ffff
    s_waitcnt vmcnt(0)
    buffer_load_dwordx4 v[180:183], v26, s[56:59], s72 offen
    s_add_u32 s72, s72, 4096
    s_and_b32 s72, s72, 0x1ffff
    s_waitcnt vmcnt(0)
    buffer_load_dwordx4 v[184:187], v26, s[56:59], s72 offen
    s_add_u32 s72, s72, 4096
    s_and_b32 s72, s72, 0x1ffff
    s_waitcnt vmcnt(0)
    buffer_load_dwordx4 v[188:191], v26, s[56:59], s72 offen
    s_add_u32 s72, s72, 4096
    s_and_b32 s72, s72, 0x1ffff
    s_waitcnt vmcnt(0)
    buffer_load_dwordx4 v[192:195], v26, s[56:59], s72 offen
    s_add_u32 s72, s72, 4096
    s_and_b32 s72, s72, 0x1ffff
    s_waitcnt vmcnt(0)
    buffer_load_dwordx4 v[196:199], v26, s[56:59], s72 offen
    s_add_u32 s72, s72, 4096
    s_and_b32 s72, s72, 0x1ffff
    s_waitcnt vmcnt(0)
    buffer_load_dwordx4 v[200:203], v26, s[56:59], s72 offen
    s_add_u32 s72, s72, 4096
    s_and_b32 s72, s72, 0x1ffff
    s_waitcnt vmcnt(0)
    buffer_load_dwordx4 v[204:207], v26, s[56:59], s72 offen
    s_add_u32 s72, s72, 4096
    s_and_b32 s72, s72, 0x1ffff
    s_waitcnt vmcnt(0)
    buffer_load_dwordx4 v[208:211], v26, s[56:59], s72 offen
    s_add_u32 s72, s72, 4096
    s_and_b32 s72, s72, 0x1ffff
    s_waitcnt vmcnt(0)
    buffer_load_dwordx4 v[212:215], v26, s[56:59], s72 offen
    s_add_u32 s72, s72, 4096
    s_and_b32 s72, s72, 0x1ffff
    s_waitcnt vmcnt(0)
    buffer_load_dwordx4 v[216:219], v26, s[56:59], s72 offen
    s_add_u32 s72, s72, 4096
    s_and_b32 s72, s72, 0x1ffff
    s_waitcnt vmcnt(0)
    buffer_load_dwordx4 v[220:223], v26, s[56:59], s72 offen
    s_add_u32 s72, s72, 4096
    s_and_b32 s72, s72, 0x1ffff
    s_waitcnt vmcnt(0)
    buffer_load_dwordx4 v[224:227], v26, s[56:59], s72 offen
    s_add_u32 s72, s72, 4096
    s_and_b32 s72, s72, 0x1ffff
    s_waitcnt vmcnt(0)
    buffer_load_dwordx4 v[228:231], v26, s[56:59], s72 offen
    s_add_u32 s72, s72, 4096
    s_and_b32 s72, s72, 0x1ffff
    s_waitcnt vmcnt(0)
    buffer_load_dwordx4 v[232:235], v26, s[56:59], s72 offen
    s_add_u32 s72, s72, 4096
    s_and_b32 s72, s72, 0x1ffff
    s_waitcnt vmcnt(0)
    buffer_load_dwordx4 v[236:239], v26, s[56:59], s72 offen
    s_add_u32 s72, s72, 4096
    s_and_b32 s72, s72, 0x1ffff
    s_waitcnt vmcnt(0)
    buffer_load_dwordx4 v[240:243], v26, s[56:59], s72 offen
    s_add_u32 s72, s72, 4096
    s_and_b32 s72, s72, 0x1ffff
    s_waitcnt vmcnt(0)
    buffer_load_dwordx4 v[244:247], v26, s[56:59], s72 offen
    s_add_u32 s72, s72, 4096
    s_and_b32 s72, s72, 0x1ffff
    s_waitcnt vmcnt(0)
    buffer_load_dwordx4 v[248:251], v26, s[56:59], s72 offen
    s_add_u32 s72, s72, 4096
    s_and_b32 s72, s72, 0x1ffff
    s_waitcnt vmcnt(0)
    buffer_load_dwordx4 v[252:255], v26, s[56:59], s72 offen
    v_lshlrev_b32 v72, 16, v60
    v_and_b32 v73, s39, v60
    v_lshlrev_b32 v74, 16, v61
    v_and_b32 v75, s39, v61
    v_lshlrev_b32 v76, 16, v62
    v_and_b32 v77, s39, v62
    v_lshlrev_b32 v78, 16, v63
    v_and_b32 v79, s39, v63
    v_lshlrev_b32 v80, 16, v68
    v_and_b32 v81, s39, v68
    v_lshlrev_b32 v82, 16, v69
    v_and_b32 v83, s39, v69
    v_lshlrev_b32 v84, 16, v70
    v_and_b32 v85, s39, v70
    v_lshlrev_b32 v86, 16, v71
    v_and_b32 v87, s39, v71
    v_mul_f32 v72, v72, v80
    v_mul_f32 v73, v73, v81
    v_mul_f32 v74, v74, v82
    v_mul_f32 v75, v75, v83
    v_mul_f32 v76, v76, v84
    v_mul_f32 v77, v77, v85
    v_mul_f32 v78, v78, v86
    v_mul_f32 v79, v79, v87
    v_cvt_pk_bf16_f32 v80, v72, v73
    v_cvt_pk_bf16_f32 v81, v74, v75
    v_cvt_pk_bf16_f32 v82, v76, v77
    v_cvt_pk_bf16_f32 v83, v78, v79
    v_lshlrev_b32 v72, 16, v80
    v_and_b32 v73, s39, v80
    v_lshlrev_b32 v74, 16, v81
    v_and_b32 v75, s39, v81
    v_lshlrev_b32 v76, 16, v82
    v_and_b32 v77, s39, v82
    v_lshlrev_b32 v78, 16, v83
    v_and_b32 v79, s39, v83
    v_add_f32 v28, v72, v73
    v_add_f32 v28, v28, v74
    v_add_f32 v28, v28, v75
    v_add_f32 v28, v28, v76
    v_add_f32 v28, v28, v77
    v_add_f32 v28, v28, v78
    v_add_f32 v28, v28, v79
    s_nop 1
    v_add_f32_dpp v28, v28, v28 row_ror:8 row_mask:0xf bank_mask:0xf
    s_nop 1
    v_add_f32_dpp v28, v28, v28 row_ror:4 row_mask:0xf bank_mask:0xf
    s_nop 1
    v_add_f32_dpp v28, v28, v28 row_ror:2 row_mask:0xf bank_mask:0xf
    s_nop 1
    v_add_f32_dpp v28, v28, v28 row_ror:1 row_mask:0xf bank_mask:0xf
    v_mov_b32 v22, v28
    s_nop 1
    v_permlane16_swap_b32 v28, v22
    v_add_f32 v28, v28, v22
    v_mov_b32 v22, v28
    s_nop 1
    v_permlane32_swap_b32 v28, v22
    v_add_f32 v28, v28, v22
    v_cvt_pk_bf16_f32 v28, v28, v28
    v_and_b32 v28, s39, v28
    v_mul_f32 v28, s44, v28
    v_sub_f32 v28, 0, v28
    v_exp_f32 v28, v28
    s_nop 0
    v_add_f32 v28, 1.0, v28
    v_rcp_f32 v28, v28
    s_nop 0
    v_cvt_pk_bf16_f32 v28, v28, v28
    v_and_b32 v28, s39, v28
    v_lshlrev_b32 v72, 16, v60
    v_and_b32 v73, s39, v60
    v_lshlrev_b32 v74, 16, v61
    v_and_b32 v75, s39, v61
    v_lshlrev_b32 v76, 16, v62
    v_and_b32 v77, s39, v62
    v_lshlrev_b32 v78, 16, v63
    v_and_b32 v79, s39, v63
    v_add_f32 v24, v72, v73
    v_add_f32 v24, v24, v74
    v_add_f32 v24, v24, v75
    v_add_f32 v24, v24, v76
    v_add_f32 v24, v24, v77
    v_add_f32 v24, v24, v78
    v_add_f32 v24, v24, v79
    s_nop 1
    v_add_f32_dpp v24, v24, v24 row_ror:8 row_mask:0xf bank_mask:0xf
    s_nop 1
    v_add_f32_dpp v24, v24, v24 row_ror:4 row_mask:0xf bank_mask:0xf
    s_nop 1
    v_add_f32_dpp v24, v24, v24 row_ror:2 row_mask:0xf bank_mask:0xf
    s_nop 1
    v_add_f32_dpp v24, v24, v24 row_ror:1 row_mask:0xf bank_mask:0xf
    v_mov_b32 v22, v24
    s_nop 1
    v_permlane16_swap_b32 v24, v22
    v_add_f32 v24, v24, v22
    v_mov_b32 v22, v24
    s_nop 1
    v_permlane32_swap_b32 v24, v22
    v_add_f32 v24, v24, v22
    v_mul_f32 v24, 0x3b000000, v24
    v_sub_f32 v72, v72, v24
    v_mul_f32 v72, v72, v72
    v_sub_f32 v73, v73, v24
    v_mul_f32 v73, v73, v73
    v_sub_f32 v74, v74, v24
    v_mul_f32 v74, v74, v74
    v_sub_f32 v75, v75, v24
    v_mul_f32 v75, v75, v75
    v_sub_f32 v76, v76, v24
    v_mul_f32 v76, v76, v76
    v_sub_f32 v77, v77, v24
    v_mul_f32 v77, v77, v77
    v_sub_f32 v78, v78, v24
    v_mul_f32 v78, v78, v78
    v_sub_f32 v79, v79, v24
    v_mul_f32 v79, v79, v79
    v_add_f32 v25, v72, v73
    v_add_f32 v25, v25, v74
    v_add_f32 v25, v25, v75
    v_add_f32 v25, v25, v76
    v_add_f32 v25, v25, v77
    v_add_f32 v25, v25, v78
    v_add_f32 v25, v25, v79
    s_nop 1
    v_add_f32_dpp v25, v25, v25 row_ror:8 row_mask:0xf bank_mask:0xf
    s_nop 1
    v_add_f32_dpp v25, v25, v25 row_ror:4 row_mask:0xf bank_mask:0xf
    s_nop 1
    v_add_f32_dpp v25, v25, v25 row_ror:2 row_mask:0xf bank_mask:0xf
    s_nop 1
    v_add_f32_dpp v25, v25, v25 row_ror:1 row_mask:0xf bank_mask:0xf
    v_mov_b32 v22, v25
    s_nop 1
    v_permlane16_swap_b32 v25, v22
    v_add_f32 v25, v25, v22
    v_mov_b32 v22, v25
    s_nop 1
    v_permlane32_swap_b32 v25, v22
    v_add_f32 v25, v25, v22
    v_mul_f32 v25, 0x3b000000, v25
    v_cvt_pk_bf16_f32 v24, v24, v24
    v_and_b32 v24, s39, v24
    v_cvt_pk_bf16_f32 v25, v25, v25
    v_and_b32 v25, s39, v25
    v_add_f32 v25, 0x3727c5ac, v25
    v_cvt_pk_bf16_f32 v25, v25, v25
    v_and_b32 v25, s39, v25
    v_sqrt_f32 v25, v25
    s_nop 0
    v_cvt_pk_bf16_f32 v25, v25, v25
    v_and_b32 v25, s39, v25
    v_lshlrev_b32 v27, 16, v27
    v_sub_f32 v27, v27, v24
    v_cvt_pk_bf16_f32 v27, v27, v27
    v_and_b32 v27, s39, v27
    v_rcp_f32 v22, v25
    s_nop 0
    v_mul_f32 v23, v27, v22
    v_fma_f32 v27, -v25, v23, v27
    v_fma_f32 v27, v27, v22, v23
    v_cvt_pk_bf16_f32 v27, v27, v27
    v_and_b32 v27, s39, v27
    v_lshlrev_b32 v36, 16, v36
    v_lshlrev_b32 v43, 16, v43
    v_lshlrev_b32 v50, 16, v50
    v_lshlrev_b32 v37, 16, v37
    v_lshlrev_b32 v44, 16, v44
    v_lshlrev_b32 v51, 16, v51
    v_lshlrev_b32 v38, 16, v38
    v_lshlrev_b32 v45, 16, v45
    v_lshlrev_b32 v52, 16, v52
    v_lshlrev_b32 v39, 16, v39
    v_lshlrev_b32 v46, 16, v46
    v_lshlrev_b32 v53, 16, v53
    v_lshlrev_b32 v40, 16, v40
    v_lshlrev_b32 v47, 16, v47
    v_lshlrev_b32 v54, 16, v54
    v_lshlrev_b32 v41, 16, v41
    v_lshlrev_b32 v48, 16, v48
    v_lshlrev_b32 v55, 16, v55
    v_lshlrev_b32 v42, 16, v42
    v_lshlrev_b32 v49, 16, v49
    v_lshlrev_b32 v56, 16, v56
    v_mov_b32 v31, 0xc0135761
    v_mov_b32 v32, 0xbdd2d3e8
    v_mov_b32 v29, 0
    v_mov_b32 v25, 0
    s_mov_b32 s50, 7
L_mlp:
    v_mul_f32_dpp v60, v36, v27 row_newbcast:0 row_mask:0xf bank_mask:0xf
    v_mul_f32_dpp v61, v36, v27 row_newbcast:1 row_mask:0xf bank_mask:0xf
    v_cvt_pk_bf16_f32 v64, v60, v61
    v_lshlrev_b32 v60, 16, v64
    v_and_b32 v61, s39, v64
    s_nop 0
    v_add_f32_dpp v60, v43, v60 row_newbcast:0 row_mask:0xf bank_mask:0xf
    v_add_f32_dpp v61, v43, v61 row_newbcast:1 row_mask:0xf bank_mask:0xf
    v_cvt_pk_bf16_f32 v64, v60, v61
    v_lshlrev_b32 v60, 16, v64
    v_and_b32 v61, s39, v64
    v_mul_f32 v62, v60, v60
    v_mul_f32 v63, v61, v61
    v_fma_f32 v62, v62, v32, v31
    v_fma_f32 v63, v63, v32, v31
    v_mul_f32 v62, v62, v60
    v_mul_f32 v63, v63, v61
    v_exp_f32 v62, v62
    v_exp_f32 v63, v63
    v_add_f32 v62, 1.0, v62
    v_add_f32 v63, 1.0, v63
    v_rcp_f32 v62, v62
    v_rcp_f32 v63, v63
    v_mul_f32 v60, v60, v62
    v_mul_f32 v61, v61, v63
    v_cvt_pk_bf16_f32 v64, v60, v61
    v_lshlrev_b32 v60, 16, v64
    v_and_b32 v61, s39, v64
    s_nop 0
    v_fmac_f32_dpp v29, v50, v60 row_newbcast:0 row_mask:0xf bank_mask:0xf
    v_fmac_f32_dpp v25, v50, v61 row_newbcast:1 row_mask:0xf bank_mask:0xf
    v_mul_f32_dpp v60, v36, v27 row_newbcast:2 row_mask:0xf bank_mask:0xf
    v_mul_f32_dpp v61, v36, v27 row_newbcast:3 row_mask:0xf bank_mask:0xf
    v_cvt_pk_bf16_f32 v64, v60, v61
    v_lshlrev_b32 v60, 16, v64
    v_and_b32 v61, s39, v64
    s_nop 0
    v_add_f32_dpp v60, v43, v60 row_newbcast:2 row_mask:0xf bank_mask:0xf
    v_add_f32_dpp v61, v43, v61 row_newbcast:3 row_mask:0xf bank_mask:0xf
    v_cvt_pk_bf16_f32 v64, v60, v61
    v_lshlrev_b32 v60, 16, v64
    v_and_b32 v61, s39, v64
    v_mul_f32 v62, v60, v60
    v_mul_f32 v63, v61, v61
    v_fma_f32 v62, v62, v32, v31
    v_fma_f32 v63, v63, v32, v31
    v_mul_f32 v62, v62, v60
    v_mul_f32 v63, v63, v61
    v_exp_f32 v62, v62
    v_exp_f32 v63, v63
    v_add_f32 v62, 1.0, v62
    v_add_f32 v63, 1.0, v63
    v_rcp_f32 v62, v62
    v_rcp_f32 v63, v63
    v_mul_f32 v60, v60, v62
    v_mul_f32 v61, v61, v63
    v_cvt_pk_bf16_f32 v64, v60, v61
    v_lshlrev_b32 v60, 16, v64
    v_and_b32 v61, s39, v64
    s_nop 0
    v_fmac_f32_dpp v29, v50, v60 row_newbcast:2 row_mask:0xf bank_mask:0xf
    v_fmac_f32_dpp v25, v50, v61 row_newbcast:3 row_mask:0xf bank_mask:0xf
    v_mul_f32_dpp v60, v36, v27 row_newbcast:4 row_mask:0xf bank_mask:0xf
    v_mul_f32_dpp v61, v36, v27 row_newbcast:5 row_mask:0xf bank_mask:0xf
    v_cvt_pk_bf16_f32 v64, v60, v61
    v_lshlrev_b32 v60, 16, v64
    v_and_b32 v61, s39, v64
    s_nop 0
    v_add_f32_dpp v60, v43, v60 row_newbcast:4 row_mask:0xf bank_mask:0xf
    v_add_f32_dpp v61, v43, v61 row_newbcast:5 row_mask:0xf bank_mask:0xf
    v_cvt_pk_bf16_f32 v64, v60, v61
    v_lshlrev_b32 v60, 16, v64
    v_and_b32 v61, s39, v64
    v_mul_f32 v62, v60, v60
    v_mul_f32 v63, v61, v61
    v_fma_f32 v62, v62, v32, v31
    v_fma_f32 v63, v63, v32, v31
    v_mul_f32 v62, v62, v60
    v_mul_f32 v63, v63, v61
    v_exp_f32 v62, v62
    v_exp_f32 v63, v63
    v_add_f32 v62, 1.0, v62
    v_add_f32 v63, 1.0, v63
    v_rcp_f32 v62, v62
    v_rcp_f32 v63, v63
    v_mul_f32 v60, v60, v62
    v_mul_f32 v61, v61, v63
    v_cvt_pk_bf16_f32 v64, v60, v61
    v_lshlrev_b32 v60, 16, v64
    v_and_b32 v61, s39, v64
    s_nop 0
    v_fmac_f32_dpp v29, v50, v60 row_newbcast:4 row_mask:0xf bank_mask:0xf
    v_fmac_f32_dpp v25, v50, v61 row_newbcast:5 row_mask:0xf bank_mask:0xf
    v_mul_f32_dpp v60, v36, v27 row_newbcast:6 row_mask:0xf bank_mask:0xf
    v_mul_f32_dpp v61, v36, v27 row_newbcast:7 row_mask:0xf bank_mask:0xf
    v_cvt_pk_bf16_f32 v64, v60, v61
    v_lshlrev_b32 v60, 16, v64
    v_and_b32 v61, s39, v64
    s_nop 0
    v_add_f32_dpp v60, v43, v60 row_newbcast:6 row_mask:0xf bank_mask:0xf
    v_add_f32_dpp v61, v43, v61 row_newbcast:7 row_mask:0xf bank_mask:0xf
    v_cvt_pk_bf16_f32 v64, v60, v61
    v_lshlrev_b32 v60, 16, v64
    v_and_b32 v61, s39, v64
    v_mul_f32 v62, v60, v60
    v_mul_f32 v63, v61, v61
    v_fma_f32 v62, v62, v32, v31
    v_fma_f32 v63, v63, v32, v31
    v_mul_f32 v62, v62, v60
    v_mul_f32 v63, v63, v61
    v_exp_f32 v62, v62
    v_exp_f32 v63, v63
    v_add_f32 v62, 1.0, v62
    v_add_f32 v63, 1.0, v63
    v_rcp_f32 v62, v62
    v_rcp_f32 v63, v63
    v_mul_f32 v60, v60, v62
    v_mul_f32 v61, v61, v63
    v_cvt_pk_bf16_f32 v64, v60, v61
    v_lshlrev_b32 v60, 16, v64
    v_and_b32 v61, s39, v64
    s_nop 0
    v_fmac_f32_dpp v29, v50, v60 row_newbcast:6 row_mask:0xf bank_mask:0xf
    v_fmac_f32_dpp v25, v50, v61 row_newbcast:7 row_mask:0xf bank_mask:0xf
    v_mul_f32_dpp v60, v36, v27 row_newbcast:8 row_mask:0xf bank_mask:0xf
    v_mul_f32_dpp v61, v36, v27 row_newbcast:9 row_mask:0xf bank_mask:0xf
    v_cvt_pk_bf16_f32 v64, v60, v61
    v_lshlrev_b32 v60, 16, v64
    v_and_b32 v61, s39, v64
    s_nop 0
    v_add_f32_dpp v60, v43, v60 row_newbcast:8 row_mask:0xf bank_mask:0xf
    v_add_f32_dpp v61, v43, v61 row_newbcast:9 row_mask:0xf bank_mask:0xf
    v_cvt_pk_bf16_f32 v64, v60, v61
    v_lshlrev_b32 v60, 16, v64
    v_and_b32 v61, s39, v64
    v_mul_f32 v62, v60, v60
    v_mul_f32 v63, v61, v61
    v_fma_f32 v62, v62, v32, v31
    v_fma_f32 v63, v63, v32, v31
    v_mul_f32 v62, v62, v60
    v_mul_f32 v63, v63, v61
    v_exp_f32 v62, v62
    v_exp_f32 v63, v63
    v_add_f32 v62, 1.0, v62
    v_add_f32 v63, 1.0, v63
    v_rcp_f32 v62, v62
    v_rcp_f32 v63, v63
    v_mul_f32 v60, v60, v62
    v_mul_f32 v61, v61, v63
    v_cvt_pk_bf16_f32 v64, v60, v61
    v_lshlrev_b32 v60, 16, v64
    v_and_b32 v61, s39, v64
    s_nop 0
    v_fmac_f32_dpp v29, v50, v60 row_newbcast:8 row_mask:0xf bank_mask:0xf
    v_fmac_f32_dpp v25, v50, v61 row_newbcast:9 row_mask:0xf bank_mask:0xf
    v_mul_f32_dpp v60, v36, v27 row_newbcast:10 row_mask:0xf bank_mask:0xf
    v_mul_f32_dpp v61, v36, v27 row_newbcast:11 row_mask:0xf bank_mask:0xf
    v_cvt_pk_bf16_f32 v64, v60, v61
    v_lshlrev_b32 v60, 16, v64
    v_and_b32 v61, s39, v64
    s_nop 0
    v_add_f32_dpp v60, v43, v60 row_newbcast:10 row_mask:0xf bank_mask:0xf
    v_add_f32_dpp v61, v43, v61 row_newbcast:11 row_mask:0xf bank_mask:0xf
    v_cvt_pk_bf16_f32 v64, v60, v61
    v_lshlrev_b32 v60, 16, v64
    v_and_b32 v61, s39, v64
    v_mul_f32 v62, v60, v60
    v_mul_f32 v63, v61, v61
    v_fma_f32 v62, v62, v32, v31
    v_fma_f32 v63, v63, v32, v31
    v_mul_f32 v62, v62, v60
    v_mul_f32 v63, v63, v61
    v_exp_f32 v62, v62
    v_exp_f32 v63, v63
    v_add_f32 v62, 1.0, v62
    v_add_f32 v63, 1.0, v63
    v_rcp_f32 v62, v62
    v_rcp_f32 v63, v63
    v_mul_f32 v60, v60, v62
    v_mul_f32 v61, v61, v63
    v_cvt_pk_bf16_f32 v64, v60, v61
    v_lshlrev_b32 v60, 16, v64
    v_and_b32 v61, s39, v64
    s_nop 0
    v_fmac_f32_dpp v29, v50, v60 row_newbcast:10 row_mask:0xf bank_mask:0xf
    v_fmac_f32_dpp v25, v50, v61 row_newbcast:11 row_mask:0xf bank_mask:0xf
    v_mul_f32_dpp v60, v36, v27 row_newbcast:12 row_mask:0xf bank_mask:0xf
    v_mul_f32_dpp v61, v36, v27 row_newbcast:13 row_mask:0xf bank_mask:0xf
    v_cvt_pk_bf16_f32 v64, v60, v61
    v_lshlrev_b32 v60, 16, v64
    v_and_b32 v61, s39, v64
    s_nop 0
    v_add_f32_dpp v60, v43, v60 row_newbcast:12 row_mask:0xf bank_mask:0xf
    v_add_f32_dpp v61, v43, v61 row_newbcast:13 row_mask:0xf bank_mask:0xf
    v_cvt_pk_bf16_f32 v64, v60, v61
    v_lshlrev_b32 v60, 16, v64
    v_and_b32 v61, s39, v64
    v_mul_f32 v62, v60, v60
    v_mul_f32 v63, v61, v61
    v_fma_f32 v62, v62, v32, v31
    v_fma_f32 v63, v63, v32, v31
    v_mul_f32 v62, v62, v60
    v_mul_f32 v63, v63, v61
    v_exp_f32 v62, v62
    v_exp_f32 v63, v63
    v_add_f32 v62, 1.0, v62
    v_add_f32 v63, 1.0, v63
    v_rcp_f32 v62, v62
    v_rcp_f32 v63, v63
    v_mul_f32 v60, v60, v62
    v_mul_f32 v61, v61, v63
    v_cvt_pk_bf16_f32 v64, v60, v61
    v_lshlrev_b32 v60, 16, v64
    v_and_b32 v61, s39, v64
    s_nop 0
    v_fmac_f32_dpp v29, v50, v60 row_newbcast:12 row_mask:0xf bank_mask:0xf
    v_fmac_f32_dpp v25, v50, v61 row_newbcast:13 row_mask:0xf bank_mask:0xf
    v_mul_f32_dpp v60, v36, v27 row_newbcast:14 row_mask:0xf bank_mask:0xf
    v_mul_f32_dpp v61, v36, v27 row_newbcast:15 row_mask:0xf bank_mask:0xf
    v_cvt_pk_bf16_f32 v64, v60, v61
    v_lshlrev_b32 v60, 16, v64
    v_and_b32 v61, s39, v64
    s_nop 0
    v_add_f32_dpp v60, v43, v60 row_newbcast:14 row_mask:0xf bank_mask:0xf
    v_add_f32_dpp v61, v43, v61 row_newbcast:15 row_mask:0xf bank_mask:0xf
    v_cvt_pk_bf16_f32 v64, v60, v61
    v_lshlrev_b32 v60, 16, v64
    v_and_b32 v61, s39, v64
    v_mul_f32 v62, v60, v60
    v_mul_f32 v63, v61, v61
    v_fma_f32 v62, v62, v32, v31
    v_fma_f32 v63, v63, v32, v31
    v_mul_f32 v62, v62, v60
    v_mul_f32 v63, v63, v61
    v_exp_f32 v62, v62
    v_exp_f32 v63, v63
    v_add_f32 v62, 1.0, v62
    v_add_f32 v63, 1.0, v63
    v_rcp_f32 v62, v62
    v_rcp_f32 v63, v63
    v_mul_f32 v60, v60, v62
    v_mul_f32 v61, v61, v63
    v_cvt_pk_bf16_f32 v64, v60, v61
    v_lshlrev_b32 v60, 16, v64
    v_and_b32 v61, s39, v64
    s_nop 0
    v_fmac_f32_dpp v29, v50, v60 row_newbcast:14 row_mask:0xf bank_mask:0xf
    v_fmac_f32_dpp v25, v50, v61 row_newbcast:15 row_mask:0xf bank_mask:0xf
    v_mov_b32 v36, v37
    v_mov_b32 v37, v38
    v_mov_b32 v38, v39
    v_mov_b32 v39, v40
    v_mov_b32 v40, v41
    v_mov_b32 v41, v42
    v_mov_b32 v43, v44
    v_mov_b32 v44, v45
    v_mov_b32 v45, v46
    v_mov_b32 v46, v47
    v_mov_b32 v47, v48
    v_mov_b32 v48, v49
    v_mov_b32 v50, v51
    v_mov_b32 v51, v52
    v_mov_b32 v52, v53
    v_mov_b32 v53, v54
    v_mov_b32 v54, v55
    v_mov_b32 v55, v56
    s_sub_u32 s50, s50, 1
    s_cmp_lg_u32 s50, 0
    s_cbranch_scc1 L_mlp
    v_add_f32 v29, v29, v25
    v_mov_b32 v22, v29
    s_nop 1
    v_permlane16_swap_b32 v29, v22
    v_add_f32 v29, v29, v22
    v_mov_b32 v22, v29
    s_nop 1
    v_permlane32_swap_b32 v29, v22
    v_add_f32 v29, v29, v22
    v_lshlrev_b32 v22, 2, v2
    s_lshl_b32 s46, s38, 6
    v_add_u32 v22, s46, v22
    s_mov_b64 exec, 0xffff
    ds_write_b32 v22, v29 offset:4352
    s_mov_b64 exec, -1
    s_lshl_b32 s48, s36, 2
    v_add_u32 v20, s48, v2
    v_and_b32 v20, 31, v20
    v_lshlrev_b32 v20, 4, v20
    v_lshl_add_u32 v20, v1, 2, v20
    s_lshl_b32 s48, s36, 2
    v_add_u32 v27, s48, v2
    v_add_u32 v27, 16, v27
    v_and_b32 v27, 31, v27
    v_lshlrev_b32 v27, 4, v27
    v_lshl_add_u32 v27, v1, 2, v27
    v_lshrrev_b32 v21, 1, v2
    v_lshlrev_b32 v21, 12, v21
    v_and_b32 v22, 1, v2
    v_lshlrev_b32 v22, 6, v22
    v_and_b32 v23, 1, v1
    v_lshl_add_u32 v22, v23, 5, v22
    v_lshrrev_b32 v23, 1, v1
    v_lshl_add_u32 v22, v23, 4, v22
    s_lshl_b32 s46, s38, 15
    s_lshl_b32 s47, s37, 7
    s_add_u32 s46, s46, s47
    v_add3_u32 v21, v21, v22, s46
    s_lshl_b32 s46, s36, 17
    s_add_u32 s46, s46, 1048576
    s_add_u32 s64, s34, s46
    s_addc_u32 s65, s35, 0
    s_mov_b32 s66, 131072
    s_mov_b32 s67, 0x20000
    s_lshl_b32 s46, s37, 12
    v_lshlrev_b32 v26, 4, v0
    v_add_u32 v26, s46, v26
    s_lshl_b32 s46, s36, 10
    s_lshl_b32 s47, s37, 5
    s_add_u32 s46, s46, s47
    s_add_u32 s68, s30, s46
    s_addc_u32 s69, s31, 0
    s_mov_b32 s70, 64
    s_mov_b32 s71, 0x20000
    v_mov_b32 v16, 0
    v_mov_b32 v17, 0
    v_mov_b32 v18, 0
    v_mov_b32 v19, 0
    v_mov_b32 v25, 0
    v_mov_b32 v77, v58
    v_mov_b32 v79, v59
    s_waitcnt vmcnt(0) lgkmcnt(0)
    s_barrier
    ds_read_b128 v[60:63], v25 offset:4096
    ds_read_b128 v[64:67], v25 offset:4112
    ds_read_b32 v68, v20 offset:2048
    ds_read_b32 v69, v27 offset:2048
    ds_read_b32 v70, v20 offset:2560
    ds_read_b32 v71, v27 offset:2560
    ds_read_b32 v72, v20 offset:3072
    ds_read_b32 v73, v27 offset:3072
    ds_read_b32 v74, v20 offset:3584
    ds_read_b32 v75, v27 offset:3584
    s_waitcnt lgkmcnt(8)
    v_max3_f32 v22, v60, v61, v62
    v_max_f32 v22, v22, v63
    v_sub_f32 v60, v60, v22
    v_sub_f32 v61, v61, v22
    v_sub_f32 v62, v62, v22
    v_sub_f32 v63, v63, v22
    v_mul_f32 v60, s44, v60
    v_mul_f32 v61, s44, v61
    v_mul_f32 v62, s44, v62
    v_mul_f32 v63, s44, v63
    v_exp_f32 v60, v60
    v_exp_f32 v61, v61
    v_exp_f32 v62, v62
    v_exp_f32 v63, v63
    v_mul_f32 v23, v60, v64
    v_fmac_f32 v23, v61, v65
    v_fmac_f32 v23, v62, v66
    v_fmac_f32 v23, v63, v67
    v_rcp_f32 v24, v23
    s_nop 0
    v_fma_f32 v22, -v23, v24, 1.0
    v_fmac_f32 v24, v22, v24
    s_waitcnt lgkmcnt(0)
    v_mul_f32 v64, v60, v68
    v_mul_f32 v65, v60, v69
    v_fmac_f32 v64, v61, v70
    v_fmac_f32 v65, v61, v71
    v_fmac_f32 v64, v62, v72
    v_fmac_f32 v65, v62, v73
    v_fmac_f32 v64, v63, v74
    v_fmac_f32 v65, v63, v75
    v_mul_f32 v64, v64, v24
    v_mul_f32 v65, v65, v24
    v_cvt_pk_bf16_f32 v64, v64, v64
    v_cvt_pk_bf16_f32 v65, v65, v65
    s_nop 0
    v_and_b32_dpp v8, v64, v4 row_newbcast:0 row_mask:0xf bank_mask:0xf
    v_and_b32_dpp v9, v64, v5 row_newbcast:0 row_mask:0xf bank_mask:0xf
    v_and_b32_dpp v10, v64, v6 row_newbcast:0 row_mask:0xf bank_mask:0xf
    v_and_b32_dpp v11, v64, v7 row_newbcast:0 row_mask:0xf bank_mask:0xf
    v_and_b32_dpp v12, v64, v4 row_newbcast:1 row_mask:0xf bank_mask:0xf
    v_and_b32_dpp v13, v64, v5 row_newbcast:1 row_mask:0xf bank_mask:0xf
    v_and_b32_dpp v14, v64, v6 row_newbcast:1 row_mask:0xf bank_mask:0xf
    v_and_b32_dpp v15, v64, v7 row_newbcast:1 row_mask:0xf bank_mask:0xf
    v_mfma_f32_16x16x32_bf16 v[16:19], v[8:11], v[128:131], v[16:19]
    v_and_b32_dpp v8, v64, v4 row_newbcast:2 row_mask:0xf bank_mask:0xf
    v_and_b32_dpp v9, v64, v5 row_newbcast:2 row_mask:0xf bank_mask:0xf
    v_and_b32_dpp v10, v64, v6 row_newbcast:2 row_mask:0xf bank_mask:0xf
    v_and_b32_dpp v11, v64, v7 row_newbcast:2 row_mask:0xf bank_mask:0xf
    v_mfma_f32_16x16x32_bf16 v[16:19], v[12:15], v[132:135], v[16:19]
    v_and_b32_dpp v12, v64, v4 row_newbcast:3 row_mask:0xf bank_mask:0xf
    v_and_b32_dpp v13, v64, v5 row_newbcast:3 row_mask:0xf bank_mask:0xf
    v_and_b32_dpp v14, v64, v6 row_newbcast:3 row_mask:0xf bank_mask:0xf
    v_and_b32_dpp v15, v64, v7 row_newbcast:3 row_mask:0xf bank_mask:0xf
    v_mfma_f32_16x16x32_bf16 v[16:19], v[8:11], v[136:139], v[16:19]
    v_and_b32_dpp v8, v64, v4 row_newbcast:4 row_mask:0xf bank_mask:0xf
    v_and_b32_dpp v9, v64, v5 row_newbcast:4 row_mask:0xf bank_mask:0xf
    v_and_b32_dpp v10, v64, v6 row_newbcast:4 row_mask:0xf bank_mask:0xf
    v_and_b32_dpp v11, v64, v7 row_newbcast:4 row_mask:0xf bank_mask:0xf
    v_mfma_f32_16x16x32_bf16 v[16:19], v[12:15], v[140:143], v[16:19]
    v_and_b32_dpp v12, v64, v4 row_newbcast:5 row_mask:0xf bank_mask:0xf
    v_and_b32_dpp v13, v64, v5 row_newbcast:5 row_mask:0xf bank_mask:0xf
    v_and_b32_dpp v14, v64, v6 row_newbcast:5 row_mask:0xf bank_mask:0xf
    v_and_b32_dpp v15, v64, v7 row_newbcast:5 row_mask:0xf bank_mask:0xf
    v_mfma_f32_16x16x32_bf16 v[16:19], v[8:11], v[144:147], v[16:19]
    v_and_b32_dpp v8, v64, v4 row_newbcast:6 row_mask:0xf bank_mask:0xf
    v_and_b32_dpp v9, v64, v5 row_newbcast:6 row_mask:0xf bank_mask:0xf
    v_and_b32_dpp v10, v64, v6 row_newbcast:6 row_mask:0xf bank_mask:0xf
    v_and_b32_dpp v11, v64, v7 row_newbcast:6 row_mask:0xf bank_mask:0xf
    v_mfma_f32_16x16x32_bf16 v[16:19], v[12:15], v[148:151], v[16:19]
    v_and_b32_dpp v12, v64, v4 row_newbcast:7 row_mask:0xf bank_mask:0xf
    v_and_b32_dpp v13, v64, v5 row_newbcast:7 row_mask:0xf bank_mask:0xf
    v_and_b32_dpp v14, v64, v6 row_newbcast:7 row_mask:0xf bank_mask:0xf
    v_and_b32_dpp v15, v64, v7 row_newbcast:7 row_mask:0xf bank_mask:0xf
    v_mfma_f32_16x16x32_bf16 v[16:19], v[8:11], v[152:155], v[16:19]
    v_and_b32_dpp v8, v64, v4 row_newbcast:8 row_mask:0xf bank_mask:0xf
    v_and_b32_dpp v9, v64, v5 row_newbcast:8 row_mask:0xf bank_mask:0xf
    v_and_b32_dpp v10, v64, v6 row_newbcast:8 row_mask:0xf bank_mask:0xf
    v_and_b32_dpp v11, v64, v7 row_newbcast:8 row_mask:0xf bank_mask:0xf
    v_mfma_f32_16x16x32_bf16 v[16:19], v[12:15], v[156:159], v[16:19]
    v_and_b32_dpp v12, v64, v4 row_newbcast:9 row_mask:0xf bank_mask:0xf
    v_and_b32_dpp v13, v64, v5 row_newbcast:9 row_mask:0xf bank_mask:0xf
    v_and_b32_dpp v14, v64, v6 row_newbcast:9 row_mask:0xf bank_mask:0xf
    v_and_b32_dpp v15, v64, v7 row_newbcast:9 row_mask:0xf bank_mask:0xf
    v_mfma_f32_16x16x32_bf16 v[16:19], v[8:11], v[160:163], v[16:19]
    v_and_b32_dpp v8, v64, v4 row_newbcast:10 row_mask:0xf bank_mask:0xf
    v_and_b32_dpp v9, v64, v5 row_newbcast:10 row_mask:0xf bank_mask:0xf
    v_and_b32_dpp v10, v64, v6 row_newbcast:10 row_mask:0xf bank_mask:0xf
    v_and_b32_dpp v11, v64, v7 row_newbcast:10 row_mask:0xf bank_mask:0xf
    v_mfma_f32_16x16x32_bf16 v[16:19], v[12:15], v[164:167], v[16:19]
    v_and_b32_dpp v12, v64, v4 row_newbcast:11 row_mask:0xf bank_mask:0xf
    v_and_b32_dpp v13, v64, v5 row_newbcast:11 row_mask:0xf bank_mask:0xf
    v_and_b32_dpp v14, v64, v6 row_newbcast:11 row_mask:0xf bank_mask:0xf
    v_and_b32_dpp v15, v64, v7 row_newbcast:11 row_mask:0xf bank_mask:0xf
    v_mfma_f32_16x16x32_bf16 v[16:19], v[8:11], v[168:171], v[16:19]
    v_and_b32_dpp v8, v64, v4 row_newbcast:12 row_mask:0xf bank_mask:0xf
    v_and_b32_dpp v9, v64, v5 row_newbcast:12 row_mask:0xf bank_mask:0xf
    v_and_b32_dpp v10, v64, v6 row_newbcast:12 row_mask:0xf bank_mask:0xf
    v_and_b32_dpp v11, v64, v7 row_newbcast:12 row_mask:0xf bank_mask:0xf
    v_mfma_f32_16x16x32_bf16 v[16:19], v[12:15], v[172:175], v[16:19]
    v_and_b32_dpp v12, v64, v4 row_newbcast:13 row_mask:0xf bank_mask:0xf
    v_and_b32_dpp v13, v64, v5 row_newbcast:13 row_mask:0xf bank_mask:0xf
    v_and_b32_dpp v14, v64, v6 row_newbcast:13 row_mask:0xf bank_mask:0xf
    v_and_b32_dpp v15, v64, v7 row_newbcast:13 row_mask:0xf bank_mask:0xf
    v_mfma_f32_16x16x32_bf16 v[16:19], v[8:11], v[176:179], v[16:19]
    v_and_b32_dpp v8, v64, v4 row_newbcast:14 row_mask:0xf bank_mask:0xf
    v_and_b32_dpp v9, v64, v5 row_newbcast:14 row_mask:0xf bank_mask:0xf
    v_and_b32_dpp v10, v64, v6 row_newbcast:14 row_mask:0xf bank_mask:0xf
    v_and_b32_dpp v11, v64, v7 row_newbcast:14 row_mask:0xf bank_mask:0xf
    v_mfma_f32_16x16x32_bf16 v[16:19], v[12:15], v[180:183], v[16:19]
    v_and_b32_dpp v12, v64, v4 row_newbcast:15 row_mask:0xf bank_mask:0xf
    v_and_b32_dpp v13, v64, v5 row_newbcast:15 row_mask:0xf bank_mask:0xf
    v_and_b32_dpp v14, v64, v6 row_newbcast:15 row_mask:0xf bank_mask:0xf
    v_and_b32_dpp v15, v64, v7 row_newbcast:15 row_mask:0xf bank_mask:0xf
    v_mfma_f32_16x16x32_bf16 v[16:19], v[8:11], v[184:187], v[16:19]
    v_and_b32_dpp v8, v65, v4 row_newbcast:0 row_mask:0xf bank_mask:0xf
    v_and_b32_dpp v9, v65, v5 row_newbcast:0 row_mask:0xf bank_mask:0xf
    v_and_b32_dpp v10, v65, v6 row_newbcast:0 row_mask:0xf bank_mask:0xf
    v_and_b32_dpp v11, v65, v7 row_newbcast:0 row_mask:0xf bank_mask:0xf
    v_mfma_f32_16x16x32_bf16 v[16:19], v[12:15], v[188:191], v[16:19]
    v_and_b32_dpp v12, v65, v4 row_newbcast:1 row_mask:0xf bank_mask:0xf
    v_and_b32_dpp v13, v65, v5 row_newbcast:1 row_mask:0xf bank_mask:0xf
    v_and_b32_dpp v14, v65, v6 row_newbcast:1 row_mask:0xf bank_mask:0xf
    v_and_b32_dpp v15, v65, v7 row_newbcast:1 row_mask:0xf bank_mask:0xf
    v_mfma_f32_16x16x32_bf16 v[16:19], v[8:11], v[192:195], v[16:19]
    v_and_b32_dpp v8, v65, v4 row_newbcast:2 row_mask:0xf bank_mask:0xf
    v_and_b32_dpp v9, v65, v5 row_newbcast:2 row_mask:0xf bank_mask:0xf
    v_and_b32_dpp v10, v65, v6 row_newbcast:2 row_mask:0xf bank_mask:0xf
    v_and_b32_dpp v11, v65, v7 row_newbcast:2 row_mask:0xf bank_mask:0xf
    v_mfma_f32_16x16x32_bf16 v[16:19], v[12:15], v[196:199], v[16:19]
    v_and_b32_dpp v12, v65, v4 row_newbcast:3 row_mask:0xf bank_mask:0xf
    v_and_b32_dpp v13, v65, v5 row_newbcast:3 row_mask:0xf bank_mask:0xf
    v_and_b32_dpp v14, v65, v6 row_newbcast:3 row_mask:0xf bank_mask:0xf
    v_and_b32_dpp v15, v65, v7 row_newbcast:3 row_mask:0xf bank_mask:0xf
    v_mfma_f32_16x16x32_bf16 v[16:19], v[8:11], v[200:203], v[16:19]
    v_and_b32_dpp v8, v65, v4 row_newbcast:4 row_mask:0xf bank_mask:0xf
    v_and_b32_dpp v9, v65, v5 row_newbcast:4 row_mask:0xf bank_mask:0xf
    v_and_b32_dpp v10, v65, v6 row_newbcast:4 row_mask:0xf bank_mask:0xf
    v_and_b32_dpp v11, v65, v7 row_newbcast:4 row_mask:0xf bank_mask:0xf
    v_mfma_f32_16x16x32_bf16 v[16:19], v[12:15], v[204:207], v[16:19]
    v_and_b32_dpp v12, v65, v4 row_newbcast:5 row_mask:0xf bank_mask:0xf
    v_and_b32_dpp v13, v65, v5 row_newbcast:5 row_mask:0xf bank_mask:0xf
    v_and_b32_dpp v14, v65, v6 row_newbcast:5 row_mask:0xf bank_mask:0xf
    v_and_b32_dpp v15, v65, v7 row_newbcast:5 row_mask:0xf bank_mask:0xf
    v_mfma_f32_16x16x32_bf16 v[16:19], v[8:11], v[208:211], v[16:19]
    v_and_b32_dpp v8, v65, v4 row_newbcast:6 row_mask:0xf bank_mask:0xf
    v_and_b32_dpp v9, v65, v5 row_newbcast:6 row_mask:0xf bank_mask:0xf
    v_and_b32_dpp v10, v65, v6 row_newbcast:6 row_mask:0xf bank_mask:0xf
    v_and_b32_dpp v11, v65, v7 row_newbcast:6 row_mask:0xf bank_mask:0xf
    v_mfma_f32_16x16x32_bf16 v[16:19], v[12:15], v[212:215], v[16:19]
    v_and_b32_dpp v12, v65, v4 row_newbcast:7 row_mask:0xf bank_mask:0xf
    v_and_b32_dpp v13, v65, v5 row_newbcast:7 row_mask:0xf bank_mask:0xf
    v_and_b32_dpp v14, v65, v6 row_newbcast:7 row_mask:0xf bank_mask:0xf
    v_and_b32_dpp v15, v65, v7 row_newbcast:7 row_mask:0xf bank_mask:0xf
    v_mfma_f32_16x16x32_bf16 v[16:19], v[8:11], v[216:219], v[16:19]
    v_and_b32_dpp v8, v65, v4 row_newbcast:8 row_mask:0xf bank_mask:0xf
    v_and_b32_dpp v9, v65, v5 row_newbcast:8 row_mask:0xf bank_mask:0xf
    v_and_b32_dpp v10, v65, v6 row_newbcast:8 row_mask:0xf bank_mask:0xf
    v_and_b32_dpp v11, v65, v7 row_newbcast:8 row_mask:0xf bank_mask:0xf
    v_mfma_f32_16x16x32_bf16 v[16:19], v[12:15], v[220:223], v[16:19]
    v_and_b32_dpp v12, v65, v4 row_newbcast:9 row_mask:0xf bank_mask:0xf
    v_and_b32_dpp v13, v65, v5 row_newbcast:9 row_mask:0xf bank_mask:0xf
    v_and_b32_dpp v14, v65, v6 row_newbcast:9 row_mask:0xf bank_mask:0xf
    v_and_b32_dpp v15, v65, v7 row_newbcast:9 row_mask:0xf bank_mask:0xf
    v_mfma_f32_16x16x32_bf16 v[16:19], v[8:11], v[224:227], v[16:19]
    v_and_b32_dpp v8, v65, v4 row_newbcast:10 row_mask:0xf bank_mask:0xf
    v_and_b32_dpp v9, v65, v5 row_newbcast:10 row_mask:0xf bank_mask:0xf
    v_and_b32_dpp v10, v65, v6 row_newbcast:10 row_mask:0xf bank_mask:0xf
    v_and_b32_dpp v11, v65, v7 row_newbcast:10 row_mask:0xf bank_mask:0xf
    v_mfma_f32_16x16x32_bf16 v[16:19], v[12:15], v[228:231], v[16:19]
    v_and_b32_dpp v12, v65, v4 row_newbcast:11 row_mask:0xf bank_mask:0xf
    v_and_b32_dpp v13, v65, v5 row_newbcast:11 row_mask:0xf bank_mask:0xf
    v_and_b32_dpp v14, v65, v6 row_newbcast:11 row_mask:0xf bank_mask:0xf
    v_and_b32_dpp v15, v65, v7 row_newbcast:11 row_mask:0xf bank_mask:0xf
    v_mfma_f32_16x16x32_bf16 v[16:19], v[8:11], v[232:235], v[16:19]
    v_and_b32_dpp v8, v65, v4 row_newbcast:12 row_mask:0xf bank_mask:0xf
    v_and_b32_dpp v9, v65, v5 row_newbcast:12 row_mask:0xf bank_mask:0xf
    v_and_b32_dpp v10, v65, v6 row_newbcast:12 row_mask:0xf bank_mask:0xf
    v_and_b32_dpp v11, v65, v7 row_newbcast:12 row_mask:0xf bank_mask:0xf
    v_mfma_f32_16x16x32_bf16 v[16:19], v[12:15], v[236:239], v[16:19]
    v_and_b32_dpp v12, v65, v4 row_newbcast:13 row_mask:0xf bank_mask:0xf
    v_and_b32_dpp v13, v65, v5 row_newbcast:13 row_mask:0xf bank_mask:0xf
    v_and_b32_dpp v14, v65, v6 row_newbcast:13 row_mask:0xf bank_mask:0xf
    v_and_b32_dpp v15, v65, v7 row_newbcast:13 row_mask:0xf bank_mask:0xf
    v_mfma_f32_16x16x32_bf16 v[16:19], v[8:11], v[240:243], v[16:19]
    v_and_b32_dpp v8, v65, v4 row_newbcast:14 row_mask:0xf bank_mask:0xf
    v_and_b32_dpp v9, v65, v5 row_newbcast:14 row_mask:0xf bank_mask:0xf
    v_and_b32_dpp v10, v65, v6 row_newbcast:14 row_mask:0xf bank_mask:0xf
    v_and_b32_dpp v11, v65, v7 row_newbcast:14 row_mask:0xf bank_mask:0xf
    v_mfma_f32_16x16x32_bf16 v[16:19], v[12:15], v[244:247], v[16:19]
    v_and_b32_dpp v12, v65, v4 row_newbcast:15 row_mask:0xf bank_mask:0xf
    v_and_b32_dpp v13, v65, v5 row_newbcast:15 row_mask:0xf bank_mask:0xf
    v_and_b32_dpp v14, v65, v6 row_newbcast:15 row_mask:0xf bank_mask:0xf
    v_and_b32_dpp v15, v65, v7 row_newbcast:15 row_mask:0xf bank_mask:0xf
    v_mfma_f32_16x16x32_bf16 v[16:19], v[8:11], v[248:251], v[16:19]
    s_nop 0
    v_mfma_f32_16x16x32_bf16 v[16:19], v[12:15], v[252:255], v[16:19]
    s_nop 7
    v_mov_b32 v76, v16
    v_mov_b32 v78, v17
    s_nop 0
    v_permlane32_swap_b32 v76, v18
    v_permlane32_swap_b32 v78, v19
    buffer_store_dwordx4 v[76:79], v21, s[64:67], 0 offen sc1
    s_cmp_ge_u32 s38, 1
    s_cbranch_scc1 L_done
    v_and_b32 v22, 7, v0
    v_lshlrev_b32 v22, 3, v22
    v_lshrrev_b32 v24, 5, v0
    v_lshl_add_u32 v22, v24, 2, v22
    ds_read_b32 v60, v22 offset:4352
    ds_read_b32 v61, v22 offset:4416
    ds_read_b32 v62, v22 offset:4480
    ds_read_b32 v63, v22 offset:4544
    v_lshrrev_b32 v57, 1, v22
    v_lshlrev_b32 v30, 16, v30
    v_sub_f32 v23, 1.0, v28
    v_cvt_pk_bf16_f32 v23, v23, v23
    v_and_b32 v23, s39, v23
    s_waitcnt lgkmcnt(0)
    v_add_f32 v60, v60, v61
    v_add_f32 v62, v62, v63
    v_add_f32 v84, v60, v62
    v_cvt_pk_bf16_f32 v84, v84, v84
    v_and_b32 v84, s39, v84
    v_add_f32 v84, v84, v30
    v_cvt_pk_bf16_f32 v84, v84, v84
    v_and_b32 v84, s39, v84
    v_mul_f32 v84, v23, v84
    v_cvt_pk_bf16_f32 v84, v84, v84
    v_and_b32 v84, s39, v84
    s_lshl_b32 s46, s51, 7
    v_mov_b32 v25, s46
    s_mov_b32 s50, 1048576
    s_mov_b64 s[84:85], -1
    s_mov_b64 s[86:87], -1
    s_mov_b64 s[88:89], -1
    s_mov_b64 s[90:91], -1
L_poll:
    s_mov_b64 exec, s[84:85]
    s_cbranch_execz L_pskip0
    buffer_load_dwordx4 v[60:63], v26, s[64:67], 0 offen offset:0 sc1
L_pskip0:
    s_mov_b64 exec, s[86:87]
    s_cbranch_execz L_pskip1
    buffer_load_dwordx4 v[64:67], v26, s[64:67], 0 offen offset:1024 sc1
L_pskip1:
    s_mov_b64 exec, s[88:89]
    s_cbranch_execz L_pskip2
    buffer_load_dwordx4 v[68:71], v26, s[64:67], 0 offen offset:2048 sc1
L_pskip2:
    s_mov_b64 exec, s[90:91]
    s_cbranch_execz L_pskip3
    buffer_load_dwordx4 v[72:75], v26, s[64:67], 0 offen offset:3072 sc1
L_pskip3:
    s_mov_b64 exec, -1
    s_sub_u32 s50, s50, 1
    s_cbranch_scc1 L_poll_out
    s_waitcnt vmcnt(0)
    v_cmp_ne_u32 s[84:85], s74, v61
    v_cmp_ne_u32 vcc, s75, v63
    s_nop 0
    s_or_b64 s[84:85], s[84:85], vcc
    v_cmp_ne_u32 s[86:87], s74, v65
    v_cmp_ne_u32 vcc, s75, v67
    s_nop 0
    s_or_b64 s[86:87], s[86:87], vcc
    v_cmp_ne_u32 s[88:89], s74, v69
    v_cmp_ne_u32 vcc, s75, v71
    s_nop 0
    s_or_b64 s[88:89], s[88:89], vcc
    v_cmp_ne_u32 s[90:91], s74, v73
    v_cmp_ne_u32 vcc, s75, v75
    s_nop 0
    s_or_b64 s[90:91], s[90:91], vcc
    s_or_b64 vcc, s[84:85], s[86:87]
    s_or_b64 s[48:49], s[88:89], s[90:91]
    s_or_b64 vcc, vcc, s[48:49]
    s_cbranch_vccnz L_poll
L_poll_out:
    v_add_f32 v60, v60, v64
    v_add_f32 v68, v68, v72
    v_add_f32 v62, v62, v66
    v_add_f32 v70, v70, v74
    v_add_f32 v60, v60, v68
    v_add_f32 v62, v62, v70
    s_nop 1
    v_permlane32_swap_b32 v60, v62
    v_add_f32 v60, v60, v62
    s_nop 1
    v_add_f32_dpp v60, v60, v60 row_ror:8 row_mask:0xf bank_mask:0xf
    v_mov_b32 v22, v60
    s_nop 1
    v_permlane16_swap_b32 v60, v22
    v_add_f32 v60, v60, v22
    v_cvt_pk_bf16_f32 v60, v60, v60
    v_and_b32 v60, s39, v60
    v_mul_f32 v60, v28, v60
    v_cvt_pk_bf16_f32 v60, v60, v60
    v_and_b32 v60, s39, v60
    v_add_f32 v60, v60, v84
    v_cvt_pk_bf16_f32 v60, v60, v60
    s_mov_b32 exec_lo, 0xff
    s_mov_b32 exec_hi, 0xff
    buffer_store_short v60, v57, s[68:71], 0 offen
    s_mov_b64 exec, 1
    buffer_store_dwordx2 v[100:101], v25, s[60:63], 0 offen
L_done:
    s_endpgm
.section .rodata,"a"
.p2align 6
.amdhsa_kernel gated_mix__mha_block_cached__mixer_token_mlp__decode_kernel
  .amdhsa_next_free_vgpr 256
  .amdhsa_next_free_sgpr 96
  .amdhsa_accum_offset 256
  .amdhsa_group_segment_fixed_size 0
  .amdhsa_kernarg_size 112
  .amdhsa_user_sgpr_count 2
  .amdhsa_user_sgpr_kernarg_segment_ptr 1
  .amdhsa_system_sgpr_workgroup_id_x 1
  .amdhsa_float_denorm_mode_32 3
.end_amdhsa_kernel
```
